```python
import torch

def _softmax(x, axis=-1):
    return torch.softmax(x, dim=axis)
def _gelu(x):
    return torch.nn.functional.gelu(x, approximate="tanh")
def _silu(x):
    return torch.nn.functional.silu(x)
def _sigmoid(x):
    return torch.sigmoid(x)
def _layernorm(x, axis=-1, eps=1e-5):
    m = x.mean(dim=axis, keepdim=True)
    v = x.var(dim=axis, keepdim=True, unbiased=False)
    return (x - m) / torch.sqrt(v + eps)
def _scatter_add(tgt, idx, src, axis=0):
    return tgt.clone().index_add_(axis, idx, src)
def _segment_sum(src, seg, n):
    out = torch.zeros((n,) + src.shape[1:], dtype=src.dtype)
    return out.index_add_(0, seg, src)
def _pad(x, pw):
    flat = tuple(v for pair in reversed(pw) for v in pair)
    return torch.nn.functional.pad(x, flat)

kernel_name = 'concat_heads__compressed_kv_cla__compressed_kv_cla__decode'

def setup_inputs():

    _w = (lambda a: (lambda t: t.to(torch.bfloat16) if t.is_floating_point() else t)(torch.as_tensor(a)))
    def _A_setup():
        B, H, Sq, Sk, D, M = 2, 16, 1, 4096, 256, 448
        Dc = 4 * D
        return {
            "x": _w((lambda *s: torch.randn(*s, dtype=torch.bfloat16) * 3.2)(B, Sq, M)),
            "c_kv": _w((lambda *s: torch.randn(*s, dtype=torch.bfloat16) * 0.05)(B, Sk, Dc)),
            "w_q": _w((lambda *s: torch.randn(*s, dtype=torch.bfloat16) * 3.2)(M, H, D) * (M ** -0.5)),
            "w_uk": _w((lambda *s: torch.randn(*s, dtype=torch.bfloat16) * 3.2)(Dc, H, D) * (Dc ** -0.5)),
            "w_uv": _w((lambda *s: torch.randn(*s, dtype=torch.bfloat16) * 0.05)(Dc, H, D) * (Dc ** -0.5)),
            "w_o": _w((lambda *s: torch.randn(*s, dtype=torch.bfloat16) * 0.05)(H, D, M) * ((H * D) ** -0.5)),
        }
    _A_in = _A_setup()

    def _B_setup():
        B, H, Sq, Sk, D, M = 2, 16, 1, 4096, 256, 448
        Dc = 4 * D
        return {
            "x": _w((lambda *s: torch.randn(*s, dtype=torch.bfloat16) * 3.2)(B, Sq, M)),
            "c_kv": _w((lambda *s: torch.randn(*s, dtype=torch.bfloat16) * 0.05)(B, Sk, Dc)),
            "w_q": _w((lambda *s: torch.randn(*s, dtype=torch.bfloat16) * 3.2)(M, H, D) * (M ** -0.5)),
            "w_uk": _w((lambda *s: torch.randn(*s, dtype=torch.bfloat16) * 3.2)(Dc, H, D) * (Dc ** -0.5)),
            "w_uv": _w((lambda *s: torch.randn(*s, dtype=torch.bfloat16) * 0.05)(Dc, H, D) * (Dc ** -0.5)),
            "w_o": _w((lambda *s: torch.randn(*s, dtype=torch.bfloat16) * 0.05)(H, D, M) * ((H * D) ** -0.5)),
        }
    _B_in = _B_setup()

    return {
        "A_x": _A_in["x"],
        "A_c_kv": _A_in["c_kv"],
        "A_w_q": _A_in["w_q"],
        "A_w_uk": _A_in["w_uk"],
        "A_w_uv": _A_in["w_uv"],
        "A_w_o": _A_in["w_o"],
        "B_x": _B_in["x"],
        "B_c_kv": _B_in["c_kv"],
        "B_w_q": _B_in["w_q"],
        "B_w_uk": _B_in["w_uk"],
        "B_w_uv": _B_in["w_uv"],
        "B_w_o": _B_in["w_o"],
    }

def reference(A_x, A_c_kv, A_w_q, A_w_uk, A_w_uv, A_w_o, B_x, B_c_kv, B_w_q, B_w_uk, B_w_uv, B_w_o):
    def _A_ref(x, c_kv, w_q, w_uk, w_uv, w_o):
        B, Sq, M = x.shape[0], x.shape[1], x.shape[2]
        Sk = c_kv.shape[1]
        H, D = w_q.shape[1], w_q.shape[2]
        q = torch.einsum("bqm,mhd->bhqd", x, w_q)
        k = torch.einsum("bkc,chd->bhkd", c_kv, w_uk)
        v = torch.einsum("bkc,chd->bhkd", c_kv, w_uv)
        scores = torch.einsum("bhqd,bhkd->bhqk", q, k) * (D ** -0.5)
        off = Sk - Sq
        qi = torch.arange(Sq)[:, None]
        kj = torch.arange(Sk)[None, :]
        cmask = kj <= (qi + off)
        scores = torch.where(cmask[None, None], scores, -1e9)
        p = _softmax(scores, axis=-1)
        ctx = torch.einsum("bhqk,bhkd->bhqd", p, v)
        return torch.einsum("bhqd,hdm->bqm", ctx, w_o)

    def _B_ref(x, c_kv, w_q, w_uk, w_uv, w_o):
        B, Sq, M = x.shape[0], x.shape[1], x.shape[2]
        Sk = c_kv.shape[1]
        H, D = w_q.shape[1], w_q.shape[2]
        q = torch.einsum("bqm,mhd->bhqd", x, w_q)
        k = torch.einsum("bkc,chd->bhkd", c_kv, w_uk)
        v = torch.einsum("bkc,chd->bhkd", c_kv, w_uv)
        scores = torch.einsum("bhqd,bhkd->bhqk", q, k) * (D ** -0.5)
        off = Sk - Sq
        qi = torch.arange(Sq)[:, None]
        kj = torch.arange(Sk)[None, :]
        cmask = kj <= (qi + off)
        scores = torch.where(cmask[None, None], scores, -1e9)
        p = _softmax(scores, axis=-1)
        ctx = torch.einsum("bhqk,bhkd->bhqd", p, v)
        return torch.einsum("bhqd,hdm->bqm", ctx, w_o)

    a = _A_ref(A_x, A_c_kv, A_w_q, A_w_uk, A_w_uv, A_w_o)
    b = _B_ref(B_x, B_c_kv, B_w_q, B_w_uk, B_w_uv, B_w_o)
    return torch.concatenate([a, b], axis=-1)
```

```asm
; @launch grid=(256,1,1) block=(1024,1,1) lds=163840
.amdgcn_target "amdgcn-amd-amdhsa--gfx950"
.text
.globl concat_heads__compressed_kv_cla__compressed_kv_cla__decode_kernel
.p2align 8
.type concat_heads__compressed_kv_cla__compressed_kv_cla__decode_kernel,@function
concat_heads__compressed_kv_cla__compressed_kv_cla__decode_kernel:
    s_cmp_ge_u32 s2, 256
    s_cbranch_scc1 L_end
    s_load_dwordx16 s[60:75], s[0:1], 0
    s_load_dwordx8 s[76:83], s[0:1], 64
    s_load_dwordx4 s[84:87], s[0:1], 96
    s_load_dwordx2 s[88:89], s[0:1], 112
    v_and_b32 v1, 63, v0
    v_lshrrev_b32 v4, 6, v0
    v_and_b32 v2, 15, v0
    v_readfirstlane_b32 s3, v4
    v_bfe_u32 v3, v0, 4, 2
    s_and_b32 s46, s2, 7
    s_lshr_b32 s47, s2, 3
    s_lshr_b32 s4, s46, 2
    s_and_b32 s46, s46, 3
    s_lshl_b32 s5, s46, 2
    s_lshr_b32 s48, s47, 3
    s_add_u32 s5, s5, s48
    s_and_b32 s6, s47, 7
    s_lshl_b32 s7, s46, 5
    s_add_u32 s7, s7, s47
    s_mov_b32 s44, 0x05040100
    s_mov_b32 s45, 0x07060302
    s_mov_b32 s10, 1792
    s_mov_b32 s11, 0x20000
    s_mov_b32 s14, 16777216
    s_mov_b32 s15, 0x20000
    s_mov_b32 s18, 3670016
    s_mov_b32 s19, 0x20000
    s_mov_b32 s22, 8388608
    s_mov_b32 s23, 0x20000
    s_mov_b32 s26, 8388608
    s_mov_b32 s27, 0x20000
    s_mov_b32 s30, 3670016
    s_mov_b32 s31, 0x20000
    s_mov_b32 s34, 18874368
    s_mov_b32 s35, 0x20000
    s_mov_b32 s38, 3584
    s_mov_b32 s39, 0x20000
    s_mov_b32 s42, 256
    s_mov_b32 s43, 0x20000
    s_sub_u32 s50, s3, 8
    s_mov_b32 s94, 0xfffffffe
    v_mov_b32 v123, 148480
    s_and_b32 s46, s3, 7
    s_lshl_b32 s46, s46, 2
    s_add_u32 s46, s46, 148480
    v_mov_b32 v125, s46
    s_cmp_lg_u32 s3, 7
    s_cbranch_scc1 L_noinit
    v_lshl_add_u32 v4, v1, 2, v123
    v_mov_b32 v5, 0
    ds_write_b32 v4, v5
L_noinit:
    s_cmp_eq_u32 s4, 0
    s_waitcnt lgkmcnt(0)
    s_cselect_b64 s[8:9], s[60:61], s[72:73]
    s_cselect_b64 s[12:13], s[62:63], s[74:75]
    s_cselect_b64 s[16:17], s[64:65], s[76:77]
    s_cselect_b64 s[20:21], s[66:67], s[78:79]
    s_cselect_b64 s[24:25], s[68:69], s[80:81]
    s_cselect_b64 s[28:29], s[70:71], s[82:83]
    s_mov_b64 s[32:33], s[88:89]
    s_mov_b64 s[36:37], s[84:85]
    s_mov_b64 s[40:41], s[86:87]
    s_lshl_b32 s46, s4, 7
    s_add_u32 s46, s46, 11010048
    s_load_dwordx2 s[92:93], s[88:89], s46
    s_cmp_ge_u32 s3, 8
    s_cbranch_scc1 L_back
    s_setprio 3
    s_barrier
    s_waitcnt lgkmcnt(0)
    s_add_u32 s92, s92, 1
    s_addc_u32 s93, s93, 0
    s_cmp_ge_u32 s3, 4
    s_cbranch_scc1 L_nos1
    v_and_b32 v5, 1, v2
    v_mul_u32_u24 v5, 896, v5
    v_lshl_add_u32 v5, v3, 4, v5
    s_lshl_b32 s46, s6, 1
    s_lshr_b32 s47, s3, 1
    s_add_u32 s46, s46, s47
    s_lshl_b32 s48, s46, 6
    buffer_load_dwordx4 v[8:11], v5, s[8:11], s48 offen
    s_lshl_b32 s46, s3, 15
    v_lshlrev_b32 v6, 4, v1
    v_add_u32 v6, s46, v6
    s_lshl_b32 s48, s3, 10
    s_add_u32 s48, s48, 131072
    v_lshlrev_b32 v7, 9, v2
    v_lshl_add_u32 v7, v3, 7, v7
    v_add_u32 v7, s48, v7
    s_mov_b32 s59, 4000000
L_lw_wq0:
    ds_read_b32 v121, v125 offset:32
    s_waitcnt lgkmcnt(0)
    v_readfirstlane_b32 s58, v121
    s_cmp_ge_u32 s58, 1
    s_cbranch_scc1 L_lwok_wq0
    s_sleep 1
    s_sub_u32 s59, s59, 1
    s_cmp_lg_u32 s59, 0
    s_cbranch_scc1 L_lw_wq0
L_lwok_wq0:
    ds_read_b128 v[48:51], v6 offset:4096
    ds_read_b128 v[52:55], v6 offset:5120
    ds_read_b128 v[56:59], v6 offset:6144
    ds_read_b128 v[60:63], v6 offset:7168
    ds_read_b128 v[64:67], v6 offset:20480
    ds_read_b128 v[68:71], v6 offset:21504
    ds_read_b128 v[72:75], v6 offset:22528
    ds_read_b128 v[76:79], v6 offset:23552
    s_waitcnt vmcnt(0) lgkmcnt(0)
    v_mov_b32 v121, 1
    s_mov_b64 exec, 1
    ds_add_u32 v123, v121 offset:12
    s_mov_b64 exec, -1
    v_perm_b32 v80, v52, v48, s44
    v_perm_b32 v81, v60, v56, s44
    v_perm_b32 v82, v68, v64, s44
    v_perm_b32 v83, v76, v72, s44
    v_perm_b32 v84, v52, v48, s45
    v_perm_b32 v85, v60, v56, s45
    v_perm_b32 v86, v68, v64, s45
    v_perm_b32 v87, v76, v72, s45
    v_mfma_f32_16x16x32_bf16 v[88:91], v[80:83], v[8:11], 0
    v_perm_b32 v80, v53, v49, s44
    v_perm_b32 v81, v61, v57, s44
    v_perm_b32 v82, v69, v65, s44
    v_perm_b32 v83, v77, v73, s44
    v_mfma_f32_16x16x32_bf16 v[92:95], v[84:87], v[8:11], 0
    v_perm_b32 v84, v53, v49, s45
    v_perm_b32 v85, v61, v57, s45
    v_perm_b32 v86, v69, v65, s45
    v_perm_b32 v87, v77, v73, s45
    v_mfma_f32_16x16x32_bf16 v[96:99], v[80:83], v[8:11], 0
    v_perm_b32 v80, v54, v50, s44
    v_perm_b32 v81, v62, v58, s44
    v_perm_b32 v82, v70, v66, s44
    v_perm_b32 v83, v78, v74, s44
    v_mfma_f32_16x16x32_bf16 v[100:103], v[84:87], v[8:11], 0
    v_perm_b32 v84, v54, v50, s45
    v_perm_b32 v85, v62, v58, s45
    v_perm_b32 v86, v70, v66, s45
    v_perm_b32 v87, v78, v74, s45
    v_mfma_f32_16x16x32_bf16 v[104:107], v[80:83], v[8:11], 0
    v_perm_b32 v80, v55, v51, s44
    v_perm_b32 v81, v63, v59, s44
    v_perm_b32 v82, v71, v67, s44
    v_perm_b32 v83, v79, v75, s44
    v_mfma_f32_16x16x32_bf16 v[108:111], v[84:87], v[8:11], 0
    v_perm_b32 v84, v55, v51, s45
    v_perm_b32 v85, v63, v59, s45
    v_perm_b32 v86, v71, v67, s45
    v_perm_b32 v87, v79, v75, s45
    v_mfma_f32_16x16x32_bf16 v[112:115], v[80:83], v[8:11], 0
    s_nop 1
    v_mfma_f32_16x16x32_bf16 v[116:119], v[84:87], v[8:11], 0
    s_nop 7
    s_mov_b32 exec_lo, 0x00030003
    s_mov_b32 exec_hi, 0x00030003
    ds_write_b128 v7, v[88:91] offset:0
    ds_write_b128 v7, v[92:95] offset:16
    ds_write_b128 v7, v[96:99] offset:32
    ds_write_b128 v7, v[100:103] offset:48
    ds_write_b128 v7, v[104:107] offset:64
    ds_write_b128 v7, v[108:111] offset:80
    ds_write_b128 v7, v[112:115] offset:96
    ds_write_b128 v7, v[116:119] offset:112
    s_mov_b64 exec, -1
    s_waitcnt lgkmcnt(0)
    v_mov_b32 v121, 1
    s_mov_b64 exec, 1
    ds_add_u32 v123, v121 offset:0
    s_mov_b64 exec, -1
    s_cmp_ge_u32 s3, 2
    s_cbranch_scc1 L_s1done
    v_bfe_u32 v6, v1, 5, 1
    v_lshlrev_b32 v6, 10, v6
    v_and_b32 v7, 31, v1
    v_lshl_add_u32 v6, v7, 4, v6
    s_lshl_b32 s46, s3, 9
    s_add_u32 s46, s46, 131072
    v_add_u32 v6, s46, v6
    v_lshlrev_b32 v7, 4, v1
    s_lshl_b32 s48, s4, 4
    s_add_u32 s48, s48, s5
    s_lshl_b32 s48, s48, 3
    s_add_u32 s48, s48, s6
    s_lshl_b32 s48, s48, 12
    s_lshl_b32 s46, s3, 11
    s_add_u32 s48, s48, s46
    s_add_u32 s48, s48, 9437184
    v_mov_b32 v98, s92
    v_mov_b32 v99, s93
    v_mov_b32 v102, s92
    v_mov_b32 v103, s93
    s_mov_b32 s59, 4000000
L_lw_s1p:
    ds_read_b32 v121, v123 offset:0
    s_waitcnt lgkmcnt(0)
    v_readfirstlane_b32 s58, v121
    s_cmp_ge_u32 s58, 4
    s_cbranch_scc1 L_lwok_s1p
    s_sleep 1
    s_sub_u32 s59, s59, 1
    s_cmp_lg_u32 s59, 0
    s_cbranch_scc1 L_lw_s1p
L_lwok_s1p:
    ds_read_b128 v[88:91], v6
    ds_read_b128 v[92:95], v6 offset:2048
    s_waitcnt lgkmcnt(0)
    v_add_f32 v96, v88, v92
    v_add_f32 v97, v89, v93
    v_add_f32 v100, v90, v94
    v_add_f32 v101, v91, v95
    s_add_u32 s46, s48, 6291456
    buffer_store_dwordx4 v[96:99], v7, s[32:35], s46 offen
    buffer_store_dwordx4 v[100:103], v7, s[32:35], s46 offen offset:1024
    buffer_store_dwordx4 v[96:99], v7, s[32:35], s48 offen sc1
    buffer_store_dwordx4 v[100:103], v7, s[32:35], s48 offen offset:1024 sc1
    s_branch L_s1done
L_nos1:
    v_subrev_u32 v5, 256, v0
    v_lshlrev_b32 v6, 4, v5
    s_lshl_b32 s48, s4, 4
    s_add_u32 s48, s48, s5
    s_lshl_b32 s48, s48, 15
    s_add_u32 s48, s48, 9437184
    s_add_u32 s49, s48, 4096
    s_add_u32 s51, s48, 8192
    s_add_u32 s52, s48, 12288
    s_add_u32 s53, s48, 16384
    s_add_u32 s54, s48, 20480
    s_add_u32 s55, s48, 24576
    v_bfe_u32 v4, v5, 7, 1
    v_lshlrev_b32 v4, 9, v4
    v_bfe_u32 v7, v5, 3, 3
    v_lshl_add_u32 v4, v7, 6, v4
    v_bfe_u32 v7, v5, 6, 1
    v_lshl_add_u32 v4, v7, 5, v4
    v_and_b32 v7, 7, v5
    v_lshl_add_u32 v4, v7, 1, v4
    v_add_u32 v4, 147456, v4
    s_mov_b32 s59, 4000000
L_lw_s1own:
    ds_read_b32 v121, v123 offset:0
    s_waitcnt lgkmcnt(0)
    v_readfirstlane_b32 s58, v121
    s_cmp_ge_u32 s58, 4
    s_cbranch_scc1 L_lwok_s1own
    s_sleep 1
    s_sub_u32 s59, s59, 1
    s_cmp_lg_u32 s59, 0
    s_cbranch_scc1 L_lw_s1own
L_lwok_s1own:
    s_sleep 4
    v_add_u32 v8, 6291456, v6
    v_mov_b32 v9, v6
    v_mov_b32 v6, v8
    s_mov_b32 s47, 0
    s_lshl_b32 s46, s3, 14
    v_lshlrev_b32 v10, 4, v1
    v_add_u32 v10, s46, v10
    s_mov_b64 s[60:61], -1
    s_mov_b64 s[62:63], -1
    s_mov_b64 s[64:65], -1
    s_mov_b64 s[66:67], -1
    s_mov_b64 s[68:69], -1
    s_mov_b64 s[70:71], -1
    s_mov_b64 s[72:73], -1
    s_mov_b32 s59, 200000
L_pm_h1:
    s_mov_b64 exec, s[60:61]
    s_cbranch_execz L_pmsk_h1_0
    buffer_load_dwordx4 v[88:91], v6, s[32:35], s48 offen sc1
L_pmsk_h1_0:
    s_mov_b64 exec, s[62:63]
    s_cbranch_execz L_pmsk_h1_1
    buffer_load_dwordx4 v[92:95], v6, s[32:35], s49 offen sc1
L_pmsk_h1_1:
    s_mov_b64 exec, s[64:65]
    s_cbranch_execz L_pmsk_h1_2
    buffer_load_dwordx4 v[96:99], v6, s[32:35], s51 offen sc1
L_pmsk_h1_2:
    s_mov_b64 exec, s[66:67]
    s_cbranch_execz L_pmsk_h1_3
    buffer_load_dwordx4 v[100:103], v6, s[32:35], s52 offen sc1
L_pmsk_h1_3:
    s_mov_b64 exec, s[68:69]
    s_cbranch_execz L_pmsk_h1_4
    buffer_load_dwordx4 v[104:107], v6, s[32:35], s53 offen sc1
L_pmsk_h1_4:
    s_mov_b64 exec, s[70:71]
    s_cbranch_execz L_pmsk_h1_5
    buffer_load_dwordx4 v[108:111], v6, s[32:35], s54 offen sc1
L_pmsk_h1_5:
    s_mov_b64 exec, s[72:73]
    s_cbranch_execz L_pmsk_h1_6
    buffer_load_dwordx4 v[112:115], v6, s[32:35], s55 offen sc1
L_pmsk_h1_6:
    s_mov_b64 exec, -1
    s_waitcnt vmcnt(0)
    v_xor_b32 v120, s92, v90
    v_xor_b32 v121, s93, v91
    v_or_b32 v120, v120, v121
    v_cmp_ne_u32 s[60:61], 0, v120
    v_xor_b32 v120, s92, v94
    v_xor_b32 v121, s93, v95
    v_or_b32 v120, v120, v121
    v_cmp_ne_u32 s[62:63], 0, v120
    v_xor_b32 v120, s92, v98
    v_xor_b32 v121, s93, v99
    v_or_b32 v120, v120, v121
    v_cmp_ne_u32 s[64:65], 0, v120
    v_xor_b32 v120, s92, v102
    v_xor_b32 v121, s93, v103
    v_or_b32 v120, v120, v121
    v_cmp_ne_u32 s[66:67], 0, v120
    v_xor_b32 v120, s92, v106
    v_xor_b32 v121, s93, v107
    v_or_b32 v120, v120, v121
    v_cmp_ne_u32 s[68:69], 0, v120
    v_xor_b32 v120, s92, v110
    v_xor_b32 v121, s93, v111
    v_or_b32 v120, v120, v121
    v_cmp_ne_u32 s[70:71], 0, v120
    v_xor_b32 v120, s92, v114
    v_xor_b32 v121, s93, v115
    v_or_b32 v120, v120, v121
    v_cmp_ne_u32 s[72:73], 0, v120
    s_nop 1
    s_or_b64 s[56:57], s[60:61], s[62:63]
    s_or_b64 s[56:57], s[56:57], s[64:65]
    s_or_b64 s[56:57], s[56:57], s[66:67]
    s_or_b64 s[56:57], s[56:57], s[68:69]
    s_or_b64 s[56:57], s[56:57], s[70:71]
    s_or_b64 s[56:57], s[56:57], s[72:73]
    s_cmp_eq_u64 s[56:57], 0
    s_cbranch_scc1 L_pmok_h1
    s_sleep 2
    s_cmp_lg_u32 s47, 0
    s_cbranch_scc1 L_h1_ukdone
    ds_read_b32 v121, v125 offset:32
    s_waitcnt lgkmcnt(0)
    v_readfirstlane_b32 s46, v121
    s_cmp_lt_u32 s46, 2
    s_cbranch_scc1 L_h1_ukdone
    ds_read_b128 v[16:19], v10 offset:8192
    ds_read_b128 v[20:23], v10 offset:9216
    ds_read_b128 v[24:27], v10 offset:10240
    ds_read_b128 v[28:31], v10 offset:11264
    ds_read_b128 v[32:35], v10 offset:12288
    ds_read_b128 v[36:39], v10 offset:13312
    ds_read_b128 v[40:43], v10 offset:14336
    ds_read_b128 v[44:47], v10 offset:15360
    s_waitcnt lgkmcnt(0)
    v_mov_b32 v121, 1
    s_mov_b64 exec, 1
    ds_write_b32 v125, v121 offset:96
    s_mov_b64 exec, -1
    s_mov_b32 s47, 1
L_h1_ukdone:
    s_and_b32 s46, s59, 1
    s_cmp_eq_u32 s46, 0
    s_cselect_b64 vcc, -1, 0
    s_nop 1
    v_cndmask_b32 v6, v8, v9, vcc
    s_sub_u32 s59, s59, 1
    s_cmp_lg_u32 s59, 0
    s_cbranch_scc1 L_pm_h1
L_pmok_h1:
    v_add_f32 v88, v88, v92
    v_add_f32 v96, v96, v100
    v_add_f32 v104, v104, v108
    v_add_f32 v88, v88, v96
    v_add_f32 v104, v104, v112
    v_add_f32 v88, v88, v104
    v_add_f32 v89, v89, v93
    v_add_f32 v97, v97, v101
    v_add_f32 v105, v105, v109
    v_add_f32 v89, v89, v97
    v_add_f32 v105, v105, v113
    v_add_f32 v89, v89, v105
    v_cvt_pk_bf16_f32 v88, v88, v89
    ds_write_b16 v4, v88
    ds_write_b16_d16_hi v4, v88 offset:16
    s_waitcnt lgkmcnt(0)
    v_mov_b32 v121, 1
    s_mov_b64 exec, 1
    ds_add_u32 v123, v121 offset:4
    s_mov_b64 exec, -1
    s_branch L_s1done2
L_s1done:
    s_mov_b32 s47, 0
L_s1done2:
    s_lshl_b32 s46, s3, 14
    v_lshlrev_b32 v7, 4, v1
    v_add_u32 v7, s46, v7
    v_and_b32 v6, 1, v2
    v_lshlrev_b32 v6, 9, v6
    v_lshl_add_u32 v6, v3, 4, v6
    v_add_u32 v6, 147456, v6
    s_cmp_lg_u32 s47, 0
    s_cbranch_scc1 L_ukdone
    s_mov_b32 s59, 4000000
L_lw_uk:
    ds_read_b32 v121, v125 offset:32
    s_waitcnt lgkmcnt(0)
    v_readfirstlane_b32 s58, v121
    s_cmp_ge_u32 s58, 2
    s_cbranch_scc1 L_lwok_uk
    s_sleep 1
    s_sub_u32 s59, s59, 1
    s_cmp_lg_u32 s59, 0
    s_cbranch_scc1 L_lw_uk
L_lwok_uk:
    ds_read_b128 v[16:19], v7 offset:8192
    ds_read_b128 v[20:23], v7 offset:9216
    ds_read_b128 v[24:27], v7 offset:10240
    ds_read_b128 v[28:31], v7 offset:11264
    ds_read_b128 v[32:35], v7 offset:12288
    ds_read_b128 v[36:39], v7 offset:13312
    ds_read_b128 v[40:43], v7 offset:14336
    ds_read_b128 v[44:47], v7 offset:15360
    s_waitcnt lgkmcnt(0)
    v_mov_b32 v121, 1
    s_mov_b64 exec, 1
    ds_write_b32 v125, v121 offset:96
    s_mov_b64 exec, -1
L_ukdone:
    s_mov_b32 s59, 4000000
L_lw_q:
    ds_read_b32 v121, v123 offset:4
    s_waitcnt lgkmcnt(0)
    v_readfirstlane_b32 s58, v121
    s_cmp_ge_u32 s58, 4
    s_cbranch_scc1 L_lwok_q
    s_sleep 1
    s_sub_u32 s59, s59, 1
    s_cmp_lg_u32 s59, 0
    s_cbranch_scc1 L_lw_q
L_lwok_q:
    ds_read_b128 v[48:51], v6 offset:0
    ds_read_b128 v[52:55], v6 offset:64
    ds_read_b128 v[56:59], v6 offset:128
    ds_read_b128 v[60:63], v6 offset:192
    ds_read_b128 v[64:67], v6 offset:256
    ds_read_b128 v[68:71], v6 offset:320
    ds_read_b128 v[72:75], v6 offset:384
    ds_read_b128 v[76:79], v6 offset:448
    v_lshlrev_b32 v6, 16, v2
    v_lshl_add_u32 v6, v3, 10, v6
    s_lshl_b32 s48, s4, 17
    s_lshl_b32 s49, s6, 13
    s_add_u32 s48, s48, s49
    s_lshl_b32 s49, s5, 6
    s_add_u32 s48, s48, s49
    s_and_b32 s49, s3, 1
    s_lshl_b32 s49, s49, 12
    s_add_u32 s48, s48, s49
    s_lshr_b32 s49, s3, 1
    s_lshl_b32 s49, s49, 4
    s_add_u32 s48, s48, s49
    s_mov_b32 s49, 0x3db8aa3b
    s_waitcnt lgkmcnt(0)
    v_mfma_f32_16x16x32_bf16 v[88:91], v[16:19], v[48:51], 0
    v_mfma_f32_16x16x32_bf16 v[88:91], v[20:23], v[52:55], v[88:91]
    v_mfma_f32_16x16x32_bf16 v[88:91], v[24:27], v[56:59], v[88:91]
    v_mfma_f32_16x16x32_bf16 v[88:91], v[28:31], v[60:63], v[88:91]
    v_mfma_f32_16x16x32_bf16 v[88:91], v[32:35], v[64:67], v[88:91]
    v_mfma_f32_16x16x32_bf16 v[88:91], v[36:39], v[68:71], v[88:91]
    v_mfma_f32_16x16x32_bf16 v[88:91], v[40:43], v[72:75], v[88:91]
    v_mfma_f32_16x16x32_bf16 v[88:91], v[44:47], v[76:79], v[88:91]
    s_nop 7
    v_mul_f32 v88, s49, v88
    v_mul_f32 v89, s49, v89
    v_mul_f32 v90, s49, v90
    v_mul_f32 v91, s49, v91
    v_cvt_pk_bf16_f32 v88, v88, v89
    v_cvt_pk_bf16_f32 v89, v90, v91
    v_mov_b32 v90, s92
    v_mov_b32 v91, s93
    s_mov_b32 exec_lo, 0x00030003
    s_mov_b32 exec_hi, 0x00030003
    buffer_store_dwordx4 v[88:91], v6, s[32:35], s48 offen sc1
    s_mov_b64 exec, -1
    s_lshl_b32 s51, s3, 14
    v_and_b32 v8, 7, v2
    v_lshlrev_b32 v8, 1, v8
    v_lshrrev_b32 v9, 3, v2
    v_or_b32 v8, v8, v9
    v_lshlrev_b32 v9, 2, v3
    v_xor_b32 v8, v8, v9
    v_lshlrev_b32 v9, 8, v2
    v_add_u32 v9, s51, v9
    v_xor_b32 v10, 0, v8
    v_lshl_add_u32 v4, v10, 4, v9
    v_xor_b32 v10, 1, v8
    v_lshl_add_u32 v5, v10, 4, v9
    v_xor_b32 v10, 2, v8
    v_lshl_add_u32 v6, v10, 4, v9
    v_xor_b32 v10, 3, v8
    v_lshl_add_u32 v7, v10, 4, v9
    v_lshrrev_b32 v112, 2, v2
    v_lshl_add_u32 v112, v3, 2, v112
    v_and_b32 v113, 7, v112
    v_lshlrev_b32 v113, 1, v113
    v_lshrrev_b32 v114, 3, v112
    v_or_b32 v113, v113, v114
    v_bfe_u32 v114, v2, 1, 1
    v_xor_b32 v113, v113, v114
    v_lshlrev_b32 v113, 4, v113
    v_and_b32 v114, 1, v2
    v_lshl_add_u32 v113, v114, 3, v113
    v_lshl_add_u32 v113, v112, 8, v113
    v_add_u32 v113, s51, v113
    v_xor_b32 v8, 0, v113
    v_xor_b32 v9, 32, v113
    v_xor_b32 v10, 64, v113
    v_xor_b32 v11, 96, v113
    v_xor_b32 v12, 128, v113
    v_xor_b32 v13, 160, v113
    v_xor_b32 v14, 192, v113
    v_xor_b32 v15, 224, v113
    v_lshlrev_b32 v113, 4, v1
    v_add_u32 v114, 65536, v113
    v_add_u32 v112, s51, v113
    s_lshr_b32 s48, s7, 6
    s_lshl_b32 s49, s4, 1
    s_add_u32 s48, s48, s49
    s_lshl_b32 s48, s48, 3
    s_add_u32 s48, s48, s3
    s_lshl_b32 s48, s48, 13
    s_add_u32 s49, s48, 4096
    v_lshlrev_b32 v124, 6, v2
    v_lshl_add_u32 v124, v3, 4, v124
    s_sleep 64
    s_mov_b32 s59, 4000000
L_lw_h2p:
    ds_read_b32 v121, v125 offset:32
    s_waitcnt lgkmcnt(0)
    v_readfirstlane_b32 s58, v121
    s_cmp_ge_u32 s58, 5
    s_cbranch_scc1 L_lwok_h2p
    s_sleep 1
    s_sub_u32 s59, s59, 1
    s_cmp_lg_u32 s59, 0
    s_cbranch_scc1 L_lw_h2p
L_lwok_h2p:
    s_mov_b64 s[60:61], -1
    s_mov_b64 s[62:63], -1
    s_mov_b64 s[64:65], -1
    s_mov_b64 s[66:67], -1
    s_mov_b64 s[68:69], -1
    s_mov_b64 s[70:71], -1
    s_mov_b64 s[72:73], -1
    s_mov_b64 s[74:75], -1
    s_mov_b32 s59, 200000
L_pm_h2:
    s_mov_b64 exec, s[60:61]
    s_cbranch_execz L_pmsk_h2_0
    buffer_load_dwordx4 v[80:83], v124, s[32:35], s48 offen offset:0 sc1
L_pmsk_h2_0:
    s_mov_b64 exec, s[62:63]
    s_cbranch_execz L_pmsk_h2_1
    buffer_load_dwordx4 v[84:87], v124, s[32:35], s48 offen offset:1024 sc1
L_pmsk_h2_1:
    s_mov_b64 exec, s[64:65]
    s_cbranch_execz L_pmsk_h2_2
    buffer_load_dwordx4 v[88:91], v124, s[32:35], s48 offen offset:2048 sc1
L_pmsk_h2_2:
    s_mov_b64 exec, s[66:67]
    s_cbranch_execz L_pmsk_h2_3
    buffer_load_dwordx4 v[92:95], v124, s[32:35], s48 offen offset:3072 sc1
L_pmsk_h2_3:
    s_mov_b64 exec, s[68:69]
    s_cbranch_execz L_pmsk_h2_4
    buffer_load_dwordx4 v[96:99], v124, s[32:35], s49 offen offset:0 sc1
L_pmsk_h2_4:
    s_mov_b64 exec, s[70:71]
    s_cbranch_execz L_pmsk_h2_5
    buffer_load_dwordx4 v[100:103], v124, s[32:35], s49 offen offset:1024 sc1
L_pmsk_h2_5:
    s_mov_b64 exec, s[72:73]
    s_cbranch_execz L_pmsk_h2_6
    buffer_load_dwordx4 v[104:107], v124, s[32:35], s49 offen offset:2048 sc1
L_pmsk_h2_6:
    s_mov_b64 exec, s[74:75]
    s_cbranch_execz L_pmsk_h2_7
    buffer_load_dwordx4 v[108:111], v124, s[32:35], s49 offen offset:3072 sc1
L_pmsk_h2_7:
    s_mov_b64 exec, -1
    s_waitcnt vmcnt(0)
    v_xor_b32 v120, s92, v82
    v_xor_b32 v121, s93, v83
    v_or_b32 v120, v120, v121
    v_cmp_ne_u32 s[60:61], 0, v120
    v_xor_b32 v120, s92, v86
    v_xor_b32 v121, s93, v87
    v_or_b32 v120, v120, v121
    v_cmp_ne_u32 s[62:63], 0, v120
    v_xor_b32 v120, s92, v90
    v_xor_b32 v121, s93, v91
    v_or_b32 v120, v120, v121
    v_cmp_ne_u32 s[64:65], 0, v120
    v_xor_b32 v120, s92, v94
    v_xor_b32 v121, s93, v95
    v_or_b32 v120, v120, v121
    v_cmp_ne_u32 s[66:67], 0, v120
    v_xor_b32 v120, s92, v98
    v_xor_b32 v121, s93, v99
    v_or_b32 v120, v120, v121
    v_cmp_ne_u32 s[68:69], 0, v120
    v_xor_b32 v120, s92, v102
    v_xor_b32 v121, s93, v103
    v_or_b32 v120, v120, v121
    v_cmp_ne_u32 s[70:71], 0, v120
    v_xor_b32 v120, s92, v106
    v_xor_b32 v121, s93, v107
    v_or_b32 v120, v120, v121
    v_cmp_ne_u32 s[72:73], 0, v120
    v_xor_b32 v120, s92, v110
    v_xor_b32 v121, s93, v111
    v_or_b32 v120, v120, v121
    v_cmp_ne_u32 s[74:75], 0, v120
    s_nop 1
    s_or_b64 s[56:57], s[60:61], s[62:63]
    s_or_b64 s[56:57], s[56:57], s[64:65]
    s_or_b64 s[56:57], s[56:57], s[66:67]
    s_or_b64 s[56:57], s[56:57], s[68:69]
    s_or_b64 s[56:57], s[56:57], s[70:71]
    s_or_b64 s[56:57], s[56:57], s[72:73]
    s_or_b64 s[56:57], s[56:57], s[74:75]
    s_cmp_eq_u64 s[56:57], 0
    s_cbranch_scc1 L_pmok_h2
    s_sleep 16
    s_sub_u32 s59, s59, 1
    s_cmp_lg_u32 s59, 0
    s_cbranch_scc1 L_pm_h2
L_pmok_h2:
    v_mov_b32 v16, v80
    v_mov_b32 v17, v81
    v_mov_b32 v18, v84
    v_mov_b32 v19, v85
    v_mov_b32 v20, v88
    v_mov_b32 v21, v89
    v_mov_b32 v22, v92
    v_mov_b32 v23, v93
    v_mov_b32 v24, v96
    v_mov_b32 v25, v97
    v_mov_b32 v26, v100
    v_mov_b32 v27, v101
    v_mov_b32 v28, v104
    v_mov_b32 v29, v105
    v_mov_b32 v30, v108
    v_mov_b32 v31, v109
    v_mov_b32 v121, 1
    s_mov_b64 exec, 1
    ds_add_u32 v123, v121 offset:8
    s_mov_b64 exec, -1
    s_mov_b32 s59, 4000000
L_lw_tile0:
    ds_read_b32 v121, v125 offset:32
    s_waitcnt lgkmcnt(0)
    v_readfirstlane_b32 s58, v121
    s_cmp_ge_u32 s58, 3
    s_cbranch_scc1 L_lwok_tile0
    s_sleep 1
    s_sub_u32 s59, s59, 1
    s_cmp_lg_u32 s59, 0
    s_cbranch_scc1 L_lw_tile0
L_lwok_tile0:
    ds_read_b128 v[32:35], v4 offset:0
    ds_read_b128 v[36:39], v5 offset:0
    ds_read_b128 v[40:43], v6 offset:0
    ds_read_b128 v[44:47], v7 offset:0
    s_waitcnt lgkmcnt(0)
    v_mfma_f32_16x16x32_bf16 v[64:67], v[32:35], v[16:19], 0
    v_mfma_f32_16x16x32_bf16 v[64:67], v[36:39], v[20:23], v[64:67]
    v_mfma_f32_16x16x32_bf16 v[64:67], v[40:43], v[24:27], v[64:67]
    v_mfma_f32_16x16x32_bf16 v[64:67], v[44:47], v[28:31], v[64:67]
    s_mov_b32 s59, 4000000
L_lw_tile1:
    ds_read_b32 v121, v125 offset:32
    s_waitcnt lgkmcnt(0)
    v_readfirstlane_b32 s58, v121
    s_cmp_ge_u32 s58, 4
    s_cbranch_scc1 L_lwok_tile1
    s_sleep 1
    s_sub_u32 s59, s59, 1
    s_cmp_lg_u32 s59, 0
    s_cbranch_scc1 L_lw_tile1
L_lwok_tile1:
    ds_read_b128 v[32:35], v4 offset:4096
    ds_read_b128 v[36:39], v5 offset:4096
    ds_read_b128 v[40:43], v6 offset:4096
    ds_read_b128 v[44:47], v7 offset:4096
    ds_read_b64_tr_b16 v[80:81], v8 offset:0
    ds_read_b64_tr_b16 v[82:83], v8 offset:4096
    ds_read_b64_tr_b16 v[84:85], v9 offset:0
    ds_read_b64_tr_b16 v[86:87], v9 offset:4096
    ds_read_b64_tr_b16 v[88:89], v10 offset:0
    ds_read_b64_tr_b16 v[90:91], v10 offset:4096
    ds_read_b64_tr_b16 v[92:93], v11 offset:0
    ds_read_b64_tr_b16 v[94:95], v11 offset:4096
    s_waitcnt lgkmcnt(8)
    v_mfma_f32_16x16x32_bf16 v[68:71], v[32:35], v[16:19], 0
    v_mfma_f32_16x16x32_bf16 v[68:71], v[36:39], v[20:23], v[68:71]
    v_mfma_f32_16x16x32_bf16 v[68:71], v[40:43], v[24:27], v[68:71]
    v_mfma_f32_16x16x32_bf16 v[68:71], v[44:47], v[28:31], v[68:71]
    s_mov_b32 s59, 4000000
L_lw_tile2:
    ds_read_b32 v121, v125 offset:32
    s_waitcnt lgkmcnt(0)
    v_readfirstlane_b32 s58, v121
    s_cmp_ge_u32 s58, 5
    s_cbranch_scc1 L_lwok_tile2
    s_sleep 1
    s_sub_u32 s59, s59, 1
    s_cmp_lg_u32 s59, 0
    s_cbranch_scc1 L_lw_tile2
L_lwok_tile2:
    ds_read_b128 v[32:35], v4 offset:8192
    ds_read_b128 v[36:39], v5 offset:8192
    ds_read_b128 v[40:43], v6 offset:8192
    ds_read_b128 v[44:47], v7 offset:8192
    ds_read_b64_tr_b16 v[96:97], v12 offset:0
    ds_read_b64_tr_b16 v[98:99], v12 offset:4096
    ds_read_b64_tr_b16 v[100:101], v13 offset:0
    ds_read_b64_tr_b16 v[102:103], v13 offset:4096
    ds_read_b64_tr_b16 v[104:105], v14 offset:0
    ds_read_b64_tr_b16 v[106:107], v14 offset:4096
    ds_read_b64_tr_b16 v[108:109], v15 offset:0
    ds_read_b64_tr_b16 v[110:111], v15 offset:4096
    s_waitcnt lgkmcnt(8)
    v_mfma_f32_16x16x32_bf16 v[72:75], v[32:35], v[16:19], 0
    v_mfma_f32_16x16x32_bf16 v[72:75], v[36:39], v[20:23], v[72:75]
    v_mfma_f32_16x16x32_bf16 v[72:75], v[40:43], v[24:27], v[72:75]
    v_mfma_f32_16x16x32_bf16 v[72:75], v[44:47], v[28:31], v[72:75]
    s_mov_b32 s59, 4000000
L_lw_tile3:
    ds_read_b32 v121, v125 offset:32
    s_waitcnt lgkmcnt(0)
    v_readfirstlane_b32 s58, v121
    s_cmp_ge_u32 s58, 6
    s_cbranch_scc1 L_lwok_tile3
    s_sleep 1
    s_sub_u32 s59, s59, 1
    s_cmp_lg_u32 s59, 0
    s_cbranch_scc1 L_lw_tile3
L_lwok_tile3:
    ds_read_b128 v[32:35], v4 offset:12288
    ds_read_b128 v[36:39], v5 offset:12288
    ds_read_b128 v[40:43], v6 offset:12288
    ds_read_b128 v[44:47], v7 offset:12288
    s_waitcnt lgkmcnt(0)
    v_mfma_f32_16x16x32_bf16 v[76:79], v[32:35], v[16:19], 0
    v_mfma_f32_16x16x32_bf16 v[76:79], v[36:39], v[20:23], v[76:79]
    v_mfma_f32_16x16x32_bf16 v[76:79], v[40:43], v[24:27], v[76:79]
    v_mfma_f32_16x16x32_bf16 v[76:79], v[44:47], v[28:31], v[76:79]
    s_nop 7
    ds_write_b128 v112, v[64:67] offset:0
    ds_write_b128 v112, v[68:71] offset:1024
    ds_write_b128 v112, v[72:75] offset:2048
    ds_write_b128 v112, v[76:79] offset:3072
    s_waitcnt lgkmcnt(0)
    v_mov_b32 v121, 1
    s_mov_b64 exec, 1
    ds_add_u32 v123, v121 offset:16
    s_mov_b64 exec, -1
    s_mov_b32 s59, 4000000
L_lw_sc:
    ds_read_b32 v121, v123 offset:16
    s_waitcnt lgkmcnt(0)
    v_readfirstlane_b32 s58, v121
    s_cmp_ge_u32 s58, 8
    s_cbranch_scc1 L_lwok_sc
    s_sleep 1
    s_sub_u32 s59, s59, 1
    s_cmp_lg_u32 s59, 0
    s_cbranch_scc1 L_lw_sc
L_lwok_sc:
    s_lshr_b32 s46, s3, 1
    s_lshl_b32 s46, s46, 10
    s_and_b32 s47, s3, 1
    s_lshl_b32 s47, s47, 3
    s_add_u32 s46, s46, s47
    v_add_u32 v115, s46, v113
    v_add_u32 v116, s46, v114
    ds_read_b64 v[16:17], v115 offset:0
    ds_read_b64 v[18:19], v115 offset:16384
    ds_read_b64 v[20:21], v115 offset:32768
    ds_read_b64 v[22:23], v115 offset:49152
    ds_read_b64 v[24:25], v116 offset:0
    ds_read_b64 v[26:27], v116 offset:16384
    ds_read_b64 v[28:29], v116 offset:32768
    ds_read_b64 v[30:31], v116 offset:49152
    v_add_u32 v117, 131072, v115
    v_add_u32 v118, 131072, v113
    s_waitcnt lgkmcnt(0)
    v_add_f32 v16, v16, v18
    v_add_f32 v20, v20, v22
    v_add_f32 v24, v24, v26
    v_add_f32 v28, v28, v30
    v_add_f32 v16, v16, v20
    v_add_f32 v24, v24, v28
    v_add_f32 v16, v16, v24
    v_add_f32 v17, v17, v19
    v_add_f32 v21, v21, v23
    v_add_f32 v25, v25, v27
    v_add_f32 v29, v29, v31
    v_add_f32 v17, v17, v21
    v_add_f32 v25, v25, v29
    v_add_f32 v17, v17, v25
    ds_write_b64 v117, v[16:17]
    s_waitcnt lgkmcnt(0)
    v_mov_b32 v121, 1
    s_mov_b64 exec, 1
    ds_add_u32 v123, v121 offset:20
    s_mov_b64 exec, -1
    s_mov_b32 s59, 4000000
L_lw_sc2:
    ds_read_b32 v121, v123 offset:20
    s_waitcnt lgkmcnt(0)
    v_readfirstlane_b32 s58, v121
    s_cmp_ge_u32 s58, 8
    s_cbranch_scc1 L_lwok_sc2
    s_sleep 1
    s_sub_u32 s59, s59, 1
    s_cmp_lg_u32 s59, 0
    s_cbranch_scc1 L_lw_sc2
L_lwok_sc2:
    ds_read_b128 v[64:67], v118 offset:0
    ds_read_b128 v[68:71], v118 offset:1024
    ds_read_b128 v[72:75], v118 offset:2048
    ds_read_b128 v[76:79], v118 offset:3072
    s_waitcnt lgkmcnt(0)
    v_max3_f32 v48, v64, v65, v66
    v_max3_f32 v48, v48, v67, v68
    v_max3_f32 v48, v48, v69, v70
    v_max3_f32 v48, v48, v71, v72
    v_max3_f32 v48, v48, v73, v74
    v_max3_f32 v48, v48, v75, v76
    v_max3_f32 v48, v48, v77, v78
    v_max_f32 v48, v48, v79
    v_mov_b32 v49, v48
    s_nop 1
    v_permlane32_swap_b32 v48, v49
    s_nop 1
    v_max_f32 v48, v48, v49
    v_mov_b32 v49, v48
    s_nop 1
    v_permlane16_swap_b32 v48, v49
    s_nop 1
    v_max_f32 v48, v48, v49
    v_sub_f32 v64, v64, v48
    v_sub_f32 v65, v65, v48
    v_sub_f32 v66, v66, v48
    v_sub_f32 v67, v67, v48
    v_sub_f32 v68, v68, v48
    v_sub_f32 v69, v69, v48
    v_sub_f32 v70, v70, v48
    v_sub_f32 v71, v71, v48
    v_sub_f32 v72, v72, v48
    v_sub_f32 v73, v73, v48
    v_sub_f32 v74, v74, v48
    v_sub_f32 v75, v75, v48
    v_sub_f32 v76, v76, v48
    v_sub_f32 v77, v77, v48
    v_sub_f32 v78, v78, v48
    v_sub_f32 v79, v79, v48
    v_exp_f32 v64, v64
    v_exp_f32 v65, v65
    v_exp_f32 v66, v66
    v_exp_f32 v67, v67
    v_exp_f32 v68, v68
    v_exp_f32 v69, v69
    v_exp_f32 v70, v70
    v_exp_f32 v71, v71
    v_exp_f32 v72, v72
    v_exp_f32 v73, v73
    v_exp_f32 v74, v74
    v_exp_f32 v75, v75
    v_exp_f32 v76, v76
    v_exp_f32 v77, v77
    v_exp_f32 v78, v78
    v_exp_f32 v79, v79
    s_nop 0
    v_cvt_pk_bf16_f32 v52, v64, v65
    v_cvt_pk_bf16_f32 v53, v66, v67
    v_cvt_pk_bf16_f32 v54, v68, v69
    v_cvt_pk_bf16_f32 v55, v70, v71
    v_cvt_pk_bf16_f32 v56, v72, v73
    v_cvt_pk_bf16_f32 v57, v74, v75
    v_cvt_pk_bf16_f32 v58, v76, v77
    v_cvt_pk_bf16_f32 v59, v78, v79
    s_nop 1
    v_mfma_f32_16x16x32_bf16 v[16:19], v[80:83], v[52:55], 0
    ds_read_b64_tr_b16 v[80:81], v8 offset:8192
    ds_read_b64_tr_b16 v[82:83], v8 offset:12288
    v_mfma_f32_16x16x32_bf16 v[20:23], v[84:87], v[52:55], 0
    ds_read_b64_tr_b16 v[84:85], v9 offset:8192
    ds_read_b64_tr_b16 v[86:87], v9 offset:12288
    v_mfma_f32_16x16x32_bf16 v[24:27], v[88:91], v[52:55], 0
    ds_read_b64_tr_b16 v[88:89], v10 offset:8192
    ds_read_b64_tr_b16 v[90:91], v10 offset:12288
    v_mfma_f32_16x16x32_bf16 v[28:31], v[92:95], v[52:55], 0
    ds_read_b64_tr_b16 v[92:93], v11 offset:8192
    ds_read_b64_tr_b16 v[94:95], v11 offset:12288
    v_mfma_f32_16x16x32_bf16 v[32:35], v[96:99], v[52:55], 0
    ds_read_b64_tr_b16 v[96:97], v12 offset:8192
    ds_read_b64_tr_b16 v[98:99], v12 offset:12288
    v_mfma_f32_16x16x32_bf16 v[36:39], v[100:103], v[52:55], 0
    ds_read_b64_tr_b16 v[100:101], v13 offset:8192
    ds_read_b64_tr_b16 v[102:103], v13 offset:12288
    v_mfma_f32_16x16x32_bf16 v[40:43], v[104:107], v[52:55], 0
    ds_read_b64_tr_b16 v[104:105], v14 offset:8192
    ds_read_b64_tr_b16 v[106:107], v14 offset:12288
    v_mfma_f32_16x16x32_bf16 v[44:47], v[108:111], v[52:55], 0
    ds_read_b64_tr_b16 v[108:109], v15 offset:8192
    ds_read_b64_tr_b16 v[110:111], v15 offset:12288
    v_add_f32 v49, v64, v65
    v_add_f32 v49, v49, v66
    v_add_f32 v49, v49, v67
    v_add_f32 v49, v49, v68
    v_add_f32 v49, v49, v69
    v_add_f32 v49, v49, v70
    v_add_f32 v49, v49, v71
    v_add_f32 v49, v49, v72
    v_add_f32 v49, v49, v73
    v_add_f32 v49, v49, v74
    v_add_f32 v49, v49, v75
    v_add_f32 v49, v49, v76
    v_add_f32 v49, v49, v77
    v_add_f32 v49, v49, v78
    v_add_f32 v49, v49, v79
    v_mov_b32 v50, v49
    s_nop 1
    v_permlane32_swap_b32 v49, v50
    s_nop 1
    v_add_f32 v49, v49, v50
    v_mov_b32 v50, v49
    s_nop 1
    v_permlane16_swap_b32 v49, v50
    s_nop 1
    v_add_f32 v49, v49, v50
    v_lshlrev_b32 v6, 6, v2
    v_lshl_add_u32 v6, v3, 4, v6
    s_lshl_b32 s48, s4, 22
    s_lshl_b32 s49, s7, 15
    s_add_u32 s48, s48, s49
    s_lshl_b32 s49, s3, 12
    s_add_u32 s48, s48, s49
    s_add_u32 s48, s48, 1048576
    s_waitcnt lgkmcnt(0)
    v_mfma_f32_16x16x32_bf16 v[16:19], v[80:83], v[56:59], v[16:19]
    v_mfma_f32_16x16x32_bf16 v[20:23], v[84:87], v[56:59], v[20:23]
    v_mfma_f32_16x16x32_bf16 v[24:27], v[88:91], v[56:59], v[24:27]
    v_mfma_f32_16x16x32_bf16 v[28:31], v[92:95], v[56:59], v[28:31]
    v_mfma_f32_16x16x32_bf16 v[32:35], v[96:99], v[56:59], v[32:35]
    v_mfma_f32_16x16x32_bf16 v[36:39], v[100:103], v[56:59], v[36:39]
    v_mfma_f32_16x16x32_bf16 v[40:43], v[104:107], v[56:59], v[40:43]
    v_mfma_f32_16x16x32_bf16 v[44:47], v[108:111], v[56:59], v[44:47]
    s_nop 3
    v_cvt_pk_bf16_f32 v80, v16, v17
    v_cvt_pk_bf16_f32 v81, v18, v19
    v_cvt_pk_bf16_f32 v82, v20, v21
    v_cvt_pk_bf16_f32 v83, v22, v23
    buffer_store_dwordx4 v[80:83], v6, s[32:35], s48 offen sc1
    s_add_u32 s48, s48, 1024
    v_cvt_pk_bf16_f32 v84, v24, v25
    v_cvt_pk_bf16_f32 v85, v26, v27
    v_cvt_pk_bf16_f32 v86, v28, v29
    v_cvt_pk_bf16_f32 v87, v30, v31
    buffer_store_dwordx4 v[84:87], v6, s[32:35], s48 offen sc1
    s_add_u32 s48, s48, 1024
    v_cvt_pk_bf16_f32 v88, v32, v33
    v_cvt_pk_bf16_f32 v89, v34, v35
    v_cvt_pk_bf16_f32 v90, v36, v37
    v_cvt_pk_bf16_f32 v91, v38, v39
    buffer_store_dwordx4 v[88:91], v6, s[32:35], s48 offen sc1
    s_add_u32 s48, s48, 1024
    v_cvt_pk_bf16_f32 v92, v40, v41
    v_cvt_pk_bf16_f32 v93, v42, v43
    v_cvt_pk_bf16_f32 v94, v44, v45
    v_cvt_pk_bf16_f32 v95, v46, v47
    buffer_store_dwordx4 v[92:95], v6, s[32:35], s48 offen sc1
    s_add_u32 s48, s48, 1024
    s_lshl_b32 s52, s4, 22
    s_and_b32 s49, s3, 1
    s_lshl_b32 s49, s49, 21
    s_add_u32 s52, s52, s49
    s_lshl_b32 s49, s6, 2
    s_lshr_b32 s53, s3, 1
    s_add_u32 s49, s49, s53
    s_lshl_b32 s49, s49, 10
    s_add_u32 s52, s52, s49
    s_lshl_b32 s49, s5, 6
    s_add_u32 s52, s52, s49
    s_add_u32 s52, s52, 1048576
    v_lshrrev_b32 v5, 2, v1
    v_lshlrev_b32 v7, 2, v5
    v_lshlrev_b32 v5, 15, v5
    v_and_b32 v4, 3, v1
    v_lshl_add_u32 v5, v4, 4, v5
    s_and_b32 s49, s3, 1
    s_lshl_b32 s49, s49, 8
    s_add_u32 s49, s49, 148736
    v_add_u32 v7, s49, v7
    v_lshlrev_b32 v6, 4, v1
    s_waitcnt vmcnt(0)
    v_mov_b32 v121, 1
    s_mov_b64 exec, 1
    ds_add_u32 v123, v121 offset:136
    s_mov_b64 exec, -1
    s_cmp_lg_u32 s3, 0
    s_cbranch_scc1 L_s3_nostat
    v_lshlrev_b32 v8, 11, v2
    s_lshl_b32 s48, s4, 15
    s_lshl_b32 s49, s7, 4
    s_add_u32 s48, s48, s49
    s_add_u32 s48, s48, 10485760
    v_mov_b32 v50, s92
    v_mov_b32 v51, s93
    s_mov_b32 s59, 4000000
L_lw_pcd:
    ds_read_b32 v121, v123 offset:136
    s_waitcnt lgkmcnt(0)
    v_readfirstlane_b32 s58, v121
    s_cmp_ge_u32 s58, 8
    s_cbranch_scc1 L_lwok_pcd
    s_sleep 1
    s_sub_u32 s59, s59, 1
    s_cmp_lg_u32 s59, 0
    s_cbranch_scc1 L_lw_pcd
L_lwok_pcd:
    s_mov_b64 exec, 0xffff
    buffer_store_dwordx4 v[48:51], v8, s[32:35], s48 offen sc1
    s_mov_b64 exec, -1
L_s3_nostat:
    s_cmp_lg_u32 s3, 7
    s_cbranch_scc1 L_nopoll3
    s_lshl_b32 s48, s4, 4
    s_add_u32 s48, s48, s5
    s_lshl_b32 s48, s48, 11
    s_add_u32 s48, s48, 10485760
    s_mov_b64 s[60:61], -1
    s_mov_b64 s[62:63], -1
    s_mov_b32 s59, 200000
L_pm_h3s:
    s_mov_b64 exec, s[60:61]
    buffer_load_dwordx4 v[64:67], v6, s[32:35], s48 offen offset:0 sc1
    s_mov_b64 exec, s[62:63]
    buffer_load_dwordx4 v[68:71], v6, s[32:35], s48 offen offset:1024 sc1
    s_mov_b64 exec, -1
    s_waitcnt vmcnt(0)
    v_xor_b32 v120, s92, v66
    v_xor_b32 v121, s93, v67
    v_or_b32 v120, v120, v121
    v_cmp_ne_u32 s[60:61], 0, v120
    v_xor_b32 v120, s92, v70
    v_xor_b32 v121, s93, v71
    v_or_b32 v120, v120, v121
    v_cmp_ne_u32 s[62:63], 0, v120
    s_nop 1
    s_or_b64 s[56:57], s[60:61], s[62:63]
    s_cmp_eq_u64 s[56:57], 0
    s_cbranch_scc1 L_pmok_h3s
    s_bcnt1_i32_b64 s56, s[60:61]
    s_bcnt1_i32_b64 s57, s[62:63]
    s_add_u32 s56, s56, s57
    s_cmp_le_u32 s56, 16
    s_cbranch_scc1 L_pmsh_h3s
    s_sleep 32
L_pmsh_h3s:
    s_sleep 2
    s_sub_u32 s59, s59, 1
    s_cmp_lg_u32 s59, 0
    s_cbranch_scc1 L_pm_h3s
L_pmok_h3s:
    v_mov_b32 v121, 1
    s_mov_b64 exec, 1
    ds_add_u32 v123, v121 offset:132
    s_mov_b64 exec, -1
L_nopoll3:
    s_mov_b32 s59, 4000000
L_lw_go3:
    ds_read_b32 v121, v123 offset:132
    s_waitcnt lgkmcnt(0)
    v_readfirstlane_b32 s58, v121
    s_cmp_ge_u32 s58, 1
    s_cbranch_scc1 L_lwok_go3
    s_sleep 1
    s_sub_u32 s59, s59, 1
    s_cmp_lg_u32 s59, 0
    s_cbranch_scc1 L_lw_go3
L_lwok_go3:
    buffer_load_dwordx4 v[16:19], v5, s[32:35], s52 offen sc1
    s_add_u32 s52, s52, 524288
    buffer_load_dwordx4 v[20:23], v5, s[32:35], s52 offen sc1
    s_add_u32 s52, s52, 524288
    buffer_load_dwordx4 v[24:27], v5, s[32:35], s52 offen sc1
    s_add_u32 s52, s52, 524288
    buffer_load_dwordx4 v[28:31], v5, s[32:35], s52 offen sc1
    s_add_u32 s52, s52, 524288
    s_cmp_lg_u32 s3, 7
    s_cbranch_scc1 L_noscl
    v_mov_b32 v80, v64
    s_nop 1
    v_max_f32_dpp v80, v80, v80 quad_perm:[1,0,3,2] row_mask:0xf bank_mask:0xf
    s_nop 1
    v_max_f32_dpp v80, v80, v80 quad_perm:[2,3,0,1] row_mask:0xf bank_mask:0xf
    s_nop 1
    v_max_f32_dpp v80, v80, v80 row_ror:4 row_mask:0xf bank_mask:0xf
    s_nop 1
    v_max_f32_dpp v80, v80, v80 row_ror:8 row_mask:0xf bank_mask:0xf
    v_mov_b32 v84, v80
    s_nop 1
    v_permlane16_swap_b32 v80, v84
    s_nop 1
    v_max_f32 v80, v80, v84
    v_mov_b32 v84, v80
    s_nop 1
    v_permlane32_swap_b32 v80, v84
    s_nop 1
    v_max_f32 v80, v80, v84
    v_sub_f32 v64, v64, v80
    v_exp_f32 v64, v64
    s_nop 0
    v_mul_f32 v81, v64, v65
    s_nop 1
    v_add_f32_dpp v81, v81, v81 quad_perm:[1,0,3,2] row_mask:0xf bank_mask:0xf
    s_nop 1
    v_add_f32_dpp v81, v81, v81 quad_perm:[2,3,0,1] row_mask:0xf bank_mask:0xf
    s_nop 1
    v_add_f32_dpp v81, v81, v81 row_ror:4 row_mask:0xf bank_mask:0xf
    s_nop 1
    v_add_f32_dpp v81, v81, v81 row_ror:8 row_mask:0xf bank_mask:0xf
    v_mov_b32 v84, v81
    s_nop 1
    v_permlane16_swap_b32 v81, v84
    s_nop 1
    v_add_f32 v81, v81, v84
    v_mov_b32 v84, v81
    s_nop 1
    v_permlane32_swap_b32 v81, v84
    s_nop 1
    v_add_f32 v81, v81, v84
    v_rcp_f32 v81, v81
    s_nop 0
    v_mul_f32 v64, v64, v81
    v_mov_b32 v80, v68
    s_nop 1
    v_max_f32_dpp v80, v80, v80 quad_perm:[1,0,3,2] row_mask:0xf bank_mask:0xf
    s_nop 1
    v_max_f32_dpp v80, v80, v80 quad_perm:[2,3,0,1] row_mask:0xf bank_mask:0xf
    s_nop 1
    v_max_f32_dpp v80, v80, v80 row_ror:4 row_mask:0xf bank_mask:0xf
    s_nop 1
    v_max_f32_dpp v80, v80, v80 row_ror:8 row_mask:0xf bank_mask:0xf
    v_mov_b32 v84, v80
    s_nop 1
    v_permlane16_swap_b32 v80, v84
    s_nop 1
    v_max_f32 v80, v80, v84
    v_mov_b32 v84, v80
    s_nop 1
    v_permlane32_swap_b32 v80, v84
    s_nop 1
    v_max_f32 v80, v80, v84
    v_sub_f32 v68, v68, v80
    v_exp_f32 v68, v68
    s_nop 0
    v_mul_f32 v81, v68, v69
    s_nop 1
    v_add_f32_dpp v81, v81, v81 quad_perm:[1,0,3,2] row_mask:0xf bank_mask:0xf
    s_nop 1
    v_add_f32_dpp v81, v81, v81 quad_perm:[2,3,0,1] row_mask:0xf bank_mask:0xf
    s_nop 1
    v_add_f32_dpp v81, v81, v81 row_ror:4 row_mask:0xf bank_mask:0xf
    s_nop 1
    v_add_f32_dpp v81, v81, v81 row_ror:8 row_mask:0xf bank_mask:0xf
    v_mov_b32 v84, v81
    s_nop 1
    v_permlane16_swap_b32 v81, v84
    s_nop 1
    v_add_f32 v81, v81, v84
    v_mov_b32 v84, v81
    s_nop 1
    v_permlane32_swap_b32 v81, v84
    s_nop 1
    v_add_f32 v81, v81, v84
    v_rcp_f32 v81, v81
    s_nop 0
    v_mul_f32 v68, v68, v81
    v_lshlrev_b32 v8, 2, v1
    v_add_u32 v8, 148736, v8
    ds_write_b32 v8, v64
    ds_write_b32 v8, v68 offset:256
    s_waitcnt lgkmcnt(0)
    v_mov_b32 v121, 1
    s_mov_b64 exec, 1
    ds_add_u32 v123, v121 offset:140
    s_mov_b64 exec, -1
L_noscl:
    s_mov_b32 s59, 4000000
L_lw_scl:
    ds_read_b32 v121, v123 offset:140
    s_waitcnt lgkmcnt(0)
    v_readfirstlane_b32 s58, v121
    s_cmp_ge_u32 s58, 1
    s_cbranch_scc1 L_lwok_scl
    s_sleep 1
    s_sub_u32 s59, s59, 1
    s_cmp_lg_u32 s59, 0
    s_cbranch_scc1 L_lw_scl
L_lwok_scl:
    ds_read_b32 v64, v7 offset:0
    ds_read_b32 v65, v7 offset:64
    ds_read_b32 v66, v7 offset:128
    ds_read_b32 v67, v7 offset:192
    v_and_b32 v6, 3, v1
    v_lshlrev_b32 v6, 4, v6
    v_bfe_u32 v7, v1, 5, 1
    v_lshl_add_u32 v6, v7, 3, v6
    v_bfe_u32 v7, v1, 4, 1
    v_lshl_add_u32 v6, v7, 2, v6
    s_lshl_b32 s48, s3, 6
    s_add_u32 s48, s48, 131072
    v_add_u32 v6, s48, v6
    s_lshr_b32 s46, s3, 1
    s_lshl_b32 s46, s46, 2
    s_add_u32 s46, s46, 148480
    v_mov_b32 v122, s46
    s_waitcnt vmcnt(0) lgkmcnt(0)
    v_lshlrev_b32 v84, 16, v16
    v_and_b32 v85, 0xffff0000, v16
    v_mul_f32 v88, v84, v64
    v_mul_f32 v89, v85, v64
    v_lshlrev_b32 v84, 16, v17
    v_and_b32 v85, 0xffff0000, v17
    v_mul_f32 v90, v84, v64
    v_mul_f32 v91, v85, v64
    v_lshlrev_b32 v84, 16, v18
    v_and_b32 v85, 0xffff0000, v18
    v_mul_f32 v92, v84, v64
    v_mul_f32 v93, v85, v64
    v_lshlrev_b32 v84, 16, v19
    v_and_b32 v85, 0xffff0000, v19
    v_mul_f32 v94, v84, v64
    v_mul_f32 v95, v85, v64
    v_lshlrev_b32 v84, 16, v20
    v_and_b32 v85, 0xffff0000, v20
    v_fmac_f32 v88, v84, v65
    v_fmac_f32 v89, v85, v65
    v_lshlrev_b32 v84, 16, v21
    v_and_b32 v85, 0xffff0000, v21
    v_fmac_f32 v90, v84, v65
    v_fmac_f32 v91, v85, v65
    v_lshlrev_b32 v84, 16, v22
    v_and_b32 v85, 0xffff0000, v22
    v_fmac_f32 v92, v84, v65
    v_fmac_f32 v93, v85, v65
    v_lshlrev_b32 v84, 16, v23
    v_and_b32 v85, 0xffff0000, v23
    v_fmac_f32 v94, v84, v65
    v_fmac_f32 v95, v85, v65
    v_lshlrev_b32 v84, 16, v24
    v_and_b32 v85, 0xffff0000, v24
    v_fmac_f32 v88, v84, v66
    v_fmac_f32 v89, v85, v66
    v_lshlrev_b32 v84, 16, v25
    v_and_b32 v85, 0xffff0000, v25
    v_fmac_f32 v90, v84, v66
    v_fmac_f32 v91, v85, v66
    v_lshlrev_b32 v84, 16, v26
    v_and_b32 v85, 0xffff0000, v26
    v_fmac_f32 v92, v84, v66
    v_fmac_f32 v93, v85, v66
    v_lshlrev_b32 v84, 16, v27
    v_and_b32 v85, 0xffff0000, v27
    v_fmac_f32 v94, v84, v66
    v_fmac_f32 v95, v85, v66
    v_lshlrev_b32 v84, 16, v28
    v_and_b32 v85, 0xffff0000, v28
    v_fmac_f32 v88, v84, v67
    v_fmac_f32 v89, v85, v67
    v_lshlrev_b32 v84, 16, v29
    v_and_b32 v85, 0xffff0000, v29
    v_fmac_f32 v90, v84, v67
    v_fmac_f32 v91, v85, v67
    v_lshlrev_b32 v84, 16, v30
    v_and_b32 v85, 0xffff0000, v30
    v_fmac_f32 v92, v84, v67
    v_fmac_f32 v93, v85, v67
    v_lshlrev_b32 v84, 16, v31
    v_and_b32 v85, 0xffff0000, v31
    v_fmac_f32 v94, v84, v67
    v_fmac_f32 v95, v85, v67
    s_nop 1
    v_permlane32_swap_b32 v88, v92
    v_permlane32_swap_b32 v89, v93
    v_permlane32_swap_b32 v90, v94
    v_permlane32_swap_b32 v91, v95
    s_nop 1
    v_add_f32 v88, v88, v92
    v_add_f32 v89, v89, v93
    v_add_f32 v90, v90, v94
    v_add_f32 v91, v91, v95
    s_nop 1
    v_permlane16_swap_b32 v88, v90
    v_permlane16_swap_b32 v89, v91
    s_nop 1
    v_add_f32 v88, v88, v90
    v_add_f32 v89, v89, v91
    s_nop 1
    v_add_f32_dpp v88, v88, v88 row_ror:4 row_mask:0xf bank_mask:0xf
    v_add_f32_dpp v89, v89, v89 row_ror:4 row_mask:0xf bank_mask:0xf
    s_nop 1
    v_add_f32_dpp v88, v88, v88 row_ror:8 row_mask:0xf bank_mask:0xf
    v_add_f32_dpp v89, v89, v89 row_ror:8 row_mask:0xf bank_mask:0xf
    v_cvt_pk_bf16_f32 v88, v88, v89
    s_mov_b32 exec_lo, 0x000f000f
    s_mov_b32 exec_hi, 0x000f000f
    ds_write_b32 v6, v88
    s_mov_b64 exec, -1
    s_waitcnt lgkmcnt(0)
    v_mov_b32 v121, 1
    s_mov_b64 exec, 1
    ds_add_u32 v122, v121 offset:64
    s_mov_b64 exec, -1
    s_endpgm
L_back:
    s_lshl_b32 s51, s50, 14
    s_lshl_b32 s65, s50, 15
    v_lshlrev_b32 v4, 16, v3
    v_lshl_add_u32 v4, v2, 4, v4
    s_lshl_b32 s63, s6, 19
    s_bfe_u32 s49, s50, 0x10001
    s_lshl_b32 s49, s49, 18
    s_add_u32 s63, s63, s49
    s_lshl_b32 s49, s5, 9
    s_add_u32 s63, s63, s49
    s_and_b32 s49, s50, 1
    s_lshl_b32 s49, s49, 8
    s_add_u32 s63, s63, s49
    s_cmp_ge_u32 s50, 4
    s_cbranch_scc1 L_nowq
    s_add_u32 s49, s65, 4096
    s_mov_b32 m0, s49
    s_nop 0
    buffer_load_dwordx4 v4, s[16:19], s63 offen nt lds
    s_add_u32 s63, s63, 8192
    s_add_u32 s49, s65, 5120
    s_mov_b32 m0, s49
    s_nop 0
    buffer_load_dwordx4 v4, s[16:19], s63 offen nt lds
    s_add_u32 s63, s63, 8192
    s_add_u32 s49, s65, 6144
    s_mov_b32 m0, s49
    s_nop 0
    buffer_load_dwordx4 v4, s[16:19], s63 offen nt lds
    s_add_u32 s63, s63, 8192
    s_add_u32 s49, s65, 7168
    s_mov_b32 m0, s49
    s_nop 0
    buffer_load_dwordx4 v4, s[16:19], s63 offen nt lds
    s_add_u32 s63, s63, 8192
    s_add_u32 s49, s65, 20480
    s_mov_b32 m0, s49
    s_nop 0
    buffer_load_dwordx4 v4, s[16:19], s63 offen nt lds
    s_add_u32 s63, s63, 8192
    s_add_u32 s49, s65, 21504
    s_mov_b32 m0, s49
    s_nop 0
    buffer_load_dwordx4 v4, s[16:19], s63 offen nt lds
    s_add_u32 s63, s63, 8192
    s_add_u32 s49, s65, 22528
    s_mov_b32 m0, s49
    s_nop 0
    buffer_load_dwordx4 v4, s[16:19], s63 offen nt lds
    s_add_u32 s63, s63, 8192
    s_add_u32 s49, s65, 23552
    s_mov_b32 m0, s49
    s_nop 0
    buffer_load_dwordx4 v4, s[16:19], s63 offen nt lds
    s_add_u32 s63, s63, 8192
L_nowq:
    v_add_u32 v120, 0, v3
    v_and_b32 v121, 7, v120
    v_lshlrev_b32 v121, 1, v121
    v_lshrrev_b32 v126, 3, v120
    v_or_b32 v121, v121, v126
    v_xor_b32 v121, v121, v2
    v_lshlrev_b32 v121, 4, v121
    v_lshl_add_u32 v116, v120, 11, v121
    v_add_u32 v120, 4, v3
    v_and_b32 v121, 7, v120
    v_lshlrev_b32 v121, 1, v121
    v_lshrrev_b32 v126, 3, v120
    v_or_b32 v121, v121, v126
    v_xor_b32 v121, v121, v2
    v_lshlrev_b32 v121, 4, v121
    v_lshl_add_u32 v117, v120, 11, v121
    v_add_u32 v120, 8, v3
    v_and_b32 v121, 7, v120
    v_lshlrev_b32 v121, 1, v121
    v_lshrrev_b32 v126, 3, v120
    v_or_b32 v121, v121, v126
    v_xor_b32 v121, v121, v2
    v_lshlrev_b32 v121, 4, v121
    v_lshl_add_u32 v118, v120, 11, v121
    v_add_u32 v120, 12, v3
    v_and_b32 v121, 7, v120
    v_lshlrev_b32 v121, 1, v121
    v_lshrrev_b32 v126, 3, v120
    v_or_b32 v121, v121, v126
    v_xor_b32 v121, v121, v2
    v_lshlrev_b32 v121, 4, v121
    v_lshl_add_u32 v119, v120, 11, v121
    s_lshl_b32 s62, s7, 17
    s_lshl_b32 s49, s50, 8
    s_add_u32 s62, s62, s49
    v_lshlrev_b32 v5, 13, v2
    v_lshl_add_u32 v5, v3, 4, v5
    s_lshl_b32 s64, s6, 20
    s_lshl_b32 s49, s50, 17
    s_add_u32 s64, s64, s49
    s_lshl_b32 s49, s5, 9
    s_add_u32 s64, s64, s49
    v_lshlrev_b32 v6, 15, v3
    v_lshl_add_u32 v6, v2, 4, v6
    s_lshl_b32 s60, s6, 20
    s_lshr_b32 s49, s50, 1
    s_lshl_b32 s49, s49, 18
    s_add_u32 s60, s60, s49
    s_lshl_b32 s49, s5, 9
    s_add_u32 s60, s60, s49
    s_and_b32 s49, s50, 1
    s_lshl_b32 s49, s49, 8
    s_add_u32 s60, s60, s49
    v_mul_u32_u24 v7, 1792, v3
    v_lshl_add_u32 v7, v2, 4, v7
    s_lshl_b32 s61, s5, 8
    s_lshl_b32 s49, s6, 5
    s_add_u32 s61, s61, s49
    s_mul_i32 s61, s61, 896
    s_and_b32 s53, s50, 3
    s_lshl_b32 s49, s53, 8
    s_add_u32 s61, s61, s49
    v_mov_b32 v9, 0x7fff0000
    s_cmp_eq_u32 s50, 7
    s_cbranch_scc0 L_nomask
    v_cmp_lt_u32 vcc, 7, v2
    s_nop 1
    v_cndmask_b32 v7, v7, v9, vcc
L_nomask:
    s_barrier
    s_cmp_ge_u32 s50, 4
    s_cbranch_scc1 L_nowq2
    s_waitcnt vmcnt(0)
    v_mov_b32 v121, 1
    s_mov_b64 exec, 1
    ds_write_b32 v125, v121 offset:32
    s_mov_b64 exec, -1
L_nowq2:
    s_add_u32 s49, s51, 8192
    s_mov_b32 m0, s49
    s_nop 0
    buffer_load_dwordx4 v5, s[20:23], s64 offen nt lds
    s_add_u32 s49, s51, 9152
    s_mov_b32 m0, s49
    s_nop 0
    buffer_load_dwordx4 v5, s[20:23], s64 offen offset:64 nt lds
    s_add_u32 s49, s51, 10112
    s_mov_b32 m0, s49
    s_nop 0
    buffer_load_dwordx4 v5, s[20:23], s64 offen offset:128 nt lds
    s_add_u32 s49, s51, 11072
    s_mov_b32 m0, s49
    s_nop 0
    buffer_load_dwordx4 v5, s[20:23], s64 offen offset:192 nt lds
    s_waitcnt vmcnt(3)
    s_add_u32 s49, s51, 12032
    s_mov_b32 m0, s49
    s_nop 0
    buffer_load_dwordx4 v5, s[20:23], s64 offen offset:256 nt lds
    s_waitcnt vmcnt(3)
    s_add_u32 s49, s51, 12992
    s_mov_b32 m0, s49
    s_nop 0
    buffer_load_dwordx4 v5, s[20:23], s64 offen offset:320 nt lds
    s_waitcnt vmcnt(3)
    s_add_u32 s49, s51, 13952
    s_mov_b32 m0, s49
    s_nop 0
    buffer_load_dwordx4 v5, s[20:23], s64 offen offset:384 nt lds
    s_waitcnt vmcnt(3)
    s_add_u32 s49, s51, 14912
    s_mov_b32 m0, s49
    s_nop 0
    buffer_load_dwordx4 v5, s[20:23], s64 offen offset:448 nt lds
    s_waitcnt vmcnt(3)
    s_add_u32 s49, s51, 0
    s_mov_b32 m0, s49
    s_nop 0
    buffer_load_dwordx4 v116, s[12:15], s62 offen nt lds
    s_waitcnt vmcnt(3)
    s_add_u32 s49, s51, 1024
    s_mov_b32 m0, s49
    s_nop 0
    buffer_load_dwordx4 v117, s[12:15], s62 offen nt lds
    s_waitcnt vmcnt(3)
    s_add_u32 s49, s51, 2048
    s_mov_b32 m0, s49
    s_nop 0
    buffer_load_dwordx4 v118, s[12:15], s62 offen nt lds
    s_waitcnt vmcnt(3)
    v_mov_b32 v121, 2
    s_mov_b64 exec, 1
    ds_write_b32 v125, v121 offset:32
    s_mov_b64 exec, -1
    s_add_u32 s49, s51, 3072
    s_mov_b32 m0, s49
    s_nop 0
    buffer_load_dwordx4 v119, s[12:15], s62 offen nt lds
    s_add_u32 s62, s62, 32768
    s_waitcnt vmcnt(3)
    s_mov_b32 s59, 4000000
L_lw_s1c:
    ds_read_b32 v121, v123 offset:12
    s_waitcnt lgkmcnt(0)
    v_readfirstlane_b32 s58, v121
    s_cmp_ge_u32 s58, 4
    s_cbranch_scc1 L_lwok_s1c
    s_sleep 1
    s_sub_u32 s59, s59, 1
    s_cmp_lg_u32 s59, 0
    s_cbranch_scc1 L_lw_s1c
L_lwok_s1c:
    s_add_u32 s49, s51, 4096
    s_mov_b32 m0, s49
    s_nop 0
    buffer_load_dwordx4 v116, s[12:15], s62 offen nt lds
    s_waitcnt vmcnt(3)
    s_add_u32 s49, s51, 5120
    s_mov_b32 m0, s49
    s_nop 0
    buffer_load_dwordx4 v117, s[12:15], s62 offen nt lds
    s_waitcnt vmcnt(3)
    s_add_u32 s49, s51, 6144
    s_mov_b32 m0, s49
    s_nop 0
    buffer_load_dwordx4 v118, s[12:15], s62 offen nt lds
    s_waitcnt vmcnt(3)
    v_mov_b32 v121, 3
    s_mov_b64 exec, 1
    ds_write_b32 v125, v121 offset:32
    s_mov_b64 exec, -1
    s_add_u32 s49, s51, 7168
    s_mov_b32 m0, s49
    s_nop 0
    buffer_load_dwordx4 v119, s[12:15], s62 offen nt lds
    s_add_u32 s62, s62, 32768
    s_waitcnt vmcnt(3)
    s_mov_b32 s59, 4000000
L_lw_s2c:
    ds_read_b32 v121, v125 offset:96
    s_waitcnt lgkmcnt(0)
    v_readfirstlane_b32 s58, v121
    s_cmp_ge_u32 s58, 1
    s_cbranch_scc1 L_lwok_s2c
    s_sleep 1
    s_sub_u32 s59, s59, 1
    s_cmp_lg_u32 s59, 0
    s_cbranch_scc1 L_lw_s2c
L_lwok_s2c:
    s_add_u32 s49, s51, 8192
    s_mov_b32 m0, s49
    s_nop 0
    buffer_load_dwordx4 v116, s[12:15], s62 offen nt lds
    s_waitcnt vmcnt(3)
    s_add_u32 s49, s51, 9216
    s_mov_b32 m0, s49
    s_nop 0
    buffer_load_dwordx4 v117, s[12:15], s62 offen nt lds
    s_waitcnt vmcnt(3)
    s_add_u32 s49, s51, 10240
    s_mov_b32 m0, s49
    s_nop 0
    buffer_load_dwordx4 v118, s[12:15], s62 offen nt lds
    s_waitcnt vmcnt(3)
    v_mov_b32 v121, 4
    s_mov_b64 exec, 1
    ds_write_b32 v125, v121 offset:32
    s_mov_b64 exec, -1
    s_add_u32 s49, s51, 11264
    s_mov_b32 m0, s49
    s_nop 0
    buffer_load_dwordx4 v119, s[12:15], s62 offen nt lds
    s_add_u32 s62, s62, 32768
    s_waitcnt vmcnt(3)
    s_add_u32 s49, s51, 12288
    s_mov_b32 m0, s49
    s_nop 0
    buffer_load_dwordx4 v116, s[12:15], s62 offen nt lds
    s_waitcnt vmcnt(3)
    s_add_u32 s49, s51, 13312
    s_mov_b32 m0, s49
    s_nop 0
    buffer_load_dwordx4 v117, s[12:15], s62 offen nt lds
    s_waitcnt vmcnt(3)
    s_add_u32 s49, s51, 14336
    s_mov_b32 m0, s49
    s_nop 0
    buffer_load_dwordx4 v118, s[12:15], s62 offen nt lds
    s_waitcnt vmcnt(3)
    v_mov_b32 v121, 5
    s_mov_b64 exec, 1
    ds_write_b32 v125, v121 offset:32
    s_mov_b64 exec, -1
    s_add_u32 s49, s51, 15360
    s_mov_b32 m0, s49
    s_nop 0
    buffer_load_dwordx4 v119, s[12:15], s62 offen nt lds
    s_waitcnt vmcnt(3)
    buffer_load_dwordx4 v[16:19], v6, s[24:27], s60 offen nt
    s_add_u32 s60, s60, 8192
    s_waitcnt vmcnt(3)
    buffer_load_dwordx4 v[20:23], v6, s[24:27], s60 offen nt
    s_add_u32 s60, s60, 8192
    s_waitcnt vmcnt(3)
    buffer_load_dwordx4 v[24:27], v6, s[24:27], s60 offen nt
    s_add_u32 s60, s60, 8192
    s_waitcnt vmcnt(3)
    v_mov_b32 v121, 6
    s_mov_b64 exec, 1
    ds_write_b32 v125, v121 offset:32
    s_mov_b64 exec, -1
    buffer_load_dwordx4 v[28:31], v6, s[24:27], s60 offen nt
    s_add_u32 s60, s60, 106496
    s_waitcnt vmcnt(3)
    buffer_load_dwordx4 v[32:35], v6, s[24:27], s60 offen nt
    s_add_u32 s60, s60, 8192
    s_waitcnt vmcnt(3)
    buffer_load_dwordx4 v[36:39], v6, s[24:27], s60 offen nt
    s_add_u32 s60, s60, 8192
    s_waitcnt vmcnt(3)
    buffer_load_dwordx4 v[40:43], v6, s[24:27], s60 offen nt
    s_add_u32 s60, s60, 8192
    s_waitcnt vmcnt(3)
    buffer_load_dwordx4 v[44:47], v6, s[24:27], s60 offen nt
    s_add_u32 s60, s60, 8192
    s_waitcnt vmcnt(3)
    s_cmp_lt_u32 s50, 4
    s_cbranch_scc1 L_nowo0
    buffer_load_dwordx4 v[48:51], v7, s[28:31], s61 offen nt
L_nowo0:
    s_add_u32 s61, s61, 7168
    s_waitcnt vmcnt(7)
    s_cmp_lt_u32 s50, 4
    s_cbranch_scc1 L_nowo1
    buffer_load_dwordx4 v[52:55], v7, s[28:31], s61 offen nt
L_nowo1:
    s_add_u32 s61, s61, 7168
    s_waitcnt vmcnt(7)
    s_cmp_lt_u32 s50, 4
    s_cbranch_scc1 L_nowo2
    buffer_load_dwordx4 v[56:59], v7, s[28:31], s61 offen nt
L_nowo2:
    s_add_u32 s61, s61, 7168
    s_waitcnt vmcnt(7)
    s_cmp_lt_u32 s50, 4
    s_cbranch_scc1 L_nowo3
    buffer_load_dwordx4 v[60:63], v7, s[28:31], s61 offen nt
L_nowo3:
    s_add_u32 s61, s61, 4294946688
    s_waitcnt vmcnt(7)
    s_cmp_lt_u32 s50, 4
    s_cbranch_scc1 L_nowo4
    buffer_load_dwordx4 v[64:67], v7, s[28:31], s61 offen nt
L_nowo4:
    s_add_u32 s61, s61, 7168
    s_waitcnt vmcnt(7)
    s_cmp_lt_u32 s50, 4
    s_cbranch_scc1 L_nowo5
    buffer_load_dwordx4 v[68:71], v7, s[28:31], s61 offen nt
L_nowo5:
    s_add_u32 s61, s61, 7168
    s_waitcnt vmcnt(7)
    s_cmp_lt_u32 s50, 4
    s_cbranch_scc1 L_nowo6
    buffer_load_dwordx4 v[72:75], v7, s[28:31], s61 offen nt
L_nowo6:
    s_add_u32 s61, s61, 7168
    s_waitcnt vmcnt(7)
    s_cmp_lt_u32 s50, 4
    s_cbranch_scc1 L_nowo7
    buffer_load_dwordx4 v[76:79], v7, s[28:31], s61 offen nt
L_nowo7:
    s_waitcnt vmcnt(7)
    s_waitcnt vmcnt(6)
    s_waitcnt vmcnt(5)
    s_waitcnt vmcnt(4)
    s_waitcnt vmcnt(3)
    s_waitcnt vmcnt(2)
    s_waitcnt vmcnt(1)
    s_waitcnt vmcnt(0)
    v_perm_b32 v112, v20, v16, s44
    v_perm_b32 v20, v20, v16, s45
    v_mov_b32 v16, v112
    v_perm_b32 v112, v29, v25, s44
    v_perm_b32 v29, v29, v25, s45
    v_mov_b32 v25, v112
    v_perm_b32 v112, v38, v34, s44
    v_perm_b32 v38, v38, v34, s45
    v_mov_b32 v34, v112
    v_perm_b32 v112, v47, v43, s44
    v_perm_b32 v47, v47, v43, s45
    v_mov_b32 v43, v112
    v_perm_b32 v112, v21, v17, s44
    v_perm_b32 v113, v21, v17, s45
    v_perm_b32 v17, v28, v24, s44
    v_perm_b32 v21, v28, v24, s45
    v_mov_b32 v24, v112
    v_mov_b32 v28, v113
    v_perm_b32 v112, v22, v18, s44
    v_perm_b32 v113, v22, v18, s45
    v_perm_b32 v18, v36, v32, s44
    v_perm_b32 v22, v36, v32, s45
    v_mov_b32 v32, v112
    v_mov_b32 v36, v113
    v_perm_b32 v112, v23, v19, s44
    v_perm_b32 v113, v23, v19, s45
    v_perm_b32 v19, v44, v40, s44
    v_perm_b32 v23, v44, v40, s45
    v_mov_b32 v40, v112
    v_mov_b32 v44, v113
    v_perm_b32 v112, v30, v26, s44
    v_perm_b32 v113, v30, v26, s45
    v_perm_b32 v26, v37, v33, s44
    v_perm_b32 v30, v37, v33, s45
    v_mov_b32 v33, v112
    v_mov_b32 v37, v113
    v_perm_b32 v112, v31, v27, s44
    v_perm_b32 v113, v31, v27, s45
    v_perm_b32 v27, v45, v41, s44
    v_perm_b32 v31, v45, v41, s45
    v_mov_b32 v41, v112
    v_mov_b32 v45, v113
    v_perm_b32 v112, v39, v35, s44
    v_perm_b32 v113, v39, v35, s45
    v_perm_b32 v35, v46, v42, s44
    v_perm_b32 v39, v46, v42, s45
    v_mov_b32 v42, v112
    v_mov_b32 v46, v113
    v_perm_b32 v112, v52, v48, s44
    v_perm_b32 v52, v52, v48, s45
    v_mov_b32 v48, v112
    v_perm_b32 v112, v61, v57, s44
    v_perm_b32 v61, v61, v57, s45
    v_mov_b32 v57, v112
    v_perm_b32 v112, v70, v66, s44
    v_perm_b32 v70, v70, v66, s45
    v_mov_b32 v66, v112
    v_perm_b32 v112, v79, v75, s44
    v_perm_b32 v79, v79, v75, s45
    v_mov_b32 v75, v112
    v_perm_b32 v112, v53, v49, s44
    v_perm_b32 v113, v53, v49, s45
    v_perm_b32 v49, v60, v56, s44
    v_perm_b32 v53, v60, v56, s45
    v_mov_b32 v56, v112
    v_mov_b32 v60, v113
    v_perm_b32 v112, v54, v50, s44
    v_perm_b32 v113, v54, v50, s45
    v_perm_b32 v50, v68, v64, s44
    v_perm_b32 v54, v68, v64, s45
    v_mov_b32 v64, v112
    v_mov_b32 v68, v113
    v_perm_b32 v112, v55, v51, s44
    v_perm_b32 v113, v55, v51, s45
    v_perm_b32 v51, v76, v72, s44
    v_perm_b32 v55, v76, v72, s45
    v_mov_b32 v72, v112
    v_mov_b32 v76, v113
    v_perm_b32 v112, v62, v58, s44
    v_perm_b32 v113, v62, v58, s45
    v_perm_b32 v58, v69, v65, s44
    v_perm_b32 v62, v69, v65, s45
    v_mov_b32 v65, v112
    v_mov_b32 v69, v113
    v_perm_b32 v112, v63, v59, s44
    v_perm_b32 v113, v63, v59, s45
    v_perm_b32 v59, v77, v73, s44
    v_perm_b32 v63, v77, v73, s45
    v_mov_b32 v73, v112
    v_mov_b32 v77, v113
    v_perm_b32 v112, v71, v67, s44
    v_perm_b32 v113, v71, v67, s45
    v_perm_b32 v67, v78, v74, s44
    v_perm_b32 v71, v78, v74, s45
    v_mov_b32 v74, v112
    v_mov_b32 v78, v113
    s_waitcnt lgkmcnt(0)
    s_add_u32 s92, s92, 1
    s_addc_u32 s93, s93, 0
    v_and_b32 v6, 1, v2
    v_lshlrev_b32 v6, 6, v6
    v_lshl_add_u32 v6, v3, 4, v6
    s_lshr_b32 s46, s50, 1
    s_lshl_b32 s48, s46, 7
    s_add_u32 s48, s48, 131072
    v_add_u32 v6, s48, v6
    s_lshl_b32 s46, s46, 2
    s_add_u32 s46, s46, 148480
    v_mov_b32 v122, s46
    v_lshlrev_b32 v8, 9, v2
    v_lshl_add_u32 v8, v3, 7, v8
    s_lshl_b32 s48, s50, 10
    s_add_u32 s48, s48, 135168
    v_add_u32 v8, s48, v8
    s_lshl_b32 s52, s4, 4
    s_add_u32 s52, s52, s5
    s_lshl_b32 s52, s52, 15
    s_mov_b32 s59, 4000000
L_lw_cl:
    ds_read_b32 v121, v122 offset:64
    s_waitcnt lgkmcnt(0)
    v_readfirstlane_b32 s58, v121
    s_cmp_ge_u32 s58, 2
    s_cbranch_scc1 L_lwok_cl
    s_sleep 1
    s_sub_u32 s59, s59, 1
    s_cmp_lg_u32 s59, 0
    s_cbranch_scc1 L_lw_cl
L_lwok_cl:
    ds_read_b128 v[4:7], v6
    s_waitcnt lgkmcnt(0)
    v_mfma_f32_16x16x32_bf16 v[80:83], v[16:19], v[4:7], 0
    v_mfma_f32_16x16x32_bf16 v[84:87], v[20:23], v[4:7], 0
    v_mfma_f32_16x16x32_bf16 v[88:91], v[24:27], v[4:7], 0
    v_mfma_f32_16x16x32_bf16 v[92:95], v[28:31], v[4:7], 0
    v_mfma_f32_16x16x32_bf16 v[96:99], v[32:35], v[4:7], 0
    v_mfma_f32_16x16x32_bf16 v[100:103], v[36:39], v[4:7], 0
    v_mfma_f32_16x16x32_bf16 v[104:107], v[40:43], v[4:7], 0
    v_mfma_f32_16x16x32_bf16 v[108:111], v[44:47], v[4:7], 0
    s_nop 7
    s_mov_b32 exec_lo, 0x00030003
    s_mov_b32 exec_hi, 0x00030003
    ds_write_b128 v8, v[80:83] offset:0
    ds_write_b128 v8, v[84:87] offset:16
    ds_write_b128 v8, v[88:91] offset:32
    ds_write_b128 v8, v[92:95] offset:48
    ds_write_b128 v8, v[96:99] offset:64
    ds_write_b128 v8, v[100:103] offset:80
    ds_write_b128 v8, v[104:107] offset:96
    ds_write_b128 v8, v[108:111] offset:112
    s_mov_b64 exec, -1
    s_waitcnt lgkmcnt(0)
    s_barrier
    s_cmp_ge_u32 s50, 4
    s_cbranch_scc1 L_s5
    v_subrev_u32 v5, 512, v0
    v_bfe_u32 v6, v5, 7, 1
    v_lshlrev_b32 v6, 10, v6
    v_bfe_u32 v7, v5, 4, 1
    v_lshl_add_u32 v6, v7, 9, v6
    v_bfe_u32 v7, v5, 5, 2
    v_lshl_add_u32 v6, v7, 7, v6
    v_and_b32 v7, 15, v5
    v_lshl_add_u32 v6, v7, 3, v6
    v_add_u32 v6, 135168, v6
    ds_read_b64 v[16:17], v6 offset:0
    ds_read_b64 v[18:19], v6 offset:2048
    ds_read_b64 v[20:21], v6 offset:4096
    ds_read_b64 v[22:23], v6 offset:6144
    v_lshlrev_b32 v5, 4, v5
    s_lshl_b32 s48, s6, 12
    s_add_u32 s48, s48, s52
    s_add_u32 s49, s48, 17825792
    s_add_u32 s48, s48, 16777216
    v_mov_b32 v26, s92
    v_mov_b32 v27, s93
    s_waitcnt lgkmcnt(0)
    v_add_f32 v16, v16, v18
    v_add_f32 v17, v17, v19
    v_add_f32 v20, v20, v22
    v_add_f32 v21, v21, v23
    v_add_f32 v24, v16, v20
    v_add_f32 v25, v17, v21
    buffer_store_dwordx4 v[24:27], v5, s[32:35], s49 offen
    buffer_store_dwordx4 v[24:27], v5, s[32:35], s48 offen sc1
    s_endpgm
L_s5:
    v_lshrrev_b32 v6, 5, v1
    v_lshlrev_b32 v6, 12, v6
    v_and_b32 v7, 31, v1
    v_lshl_add_u32 v6, v7, 4, v6
    v_add_u32 v8, 1048576, v6
    v_mov_b32 v9, v6
    v_mov_b32 v6, v8
    s_lshl_b32 s48, s6, 9
    s_add_u32 s48, s48, s52
    s_add_u32 s48, s48, 16777216
    s_add_u32 s49, s48, 8192
    s_add_u32 s51, s48, 16384
    s_add_u32 s53, s48, 24576
    s_and_b32 s46, s50, 3
    s_lshl_b32 s47, s46, 7
    s_add_u32 s47, s47, 143360
    v_lshlrev_b32 v10, 2, v7
    v_add_u32 v10, s47, v10
    v_and_b32 v11, 1, v2
    v_lshlrev_b32 v11, 6, v11
    v_lshl_add_u32 v11, v3, 4, v11
    v_add_u32 v11, s47, v11
    s_lshl_b32 s47, s46, 10
    s_add_u32 s47, s47, 16384
    v_lshlrev_b32 v12, 9, v2
    v_lshl_add_u32 v12, v3, 7, v12
    v_add_u32 v12, s47, v12
    v_lshlrev_b32 v13, 4, v1
    v_add_u32 v13, s47, v13
    s_lshl_b32 s47, s46, 5
    v_add_u32 v14, s47, v7
    v_cmp_gt_u32 vcc, 112, v14
    v_lshrrev_b32 v15, 5, v1
    v_mul_u32_u24 v15, 112, v15
    v_add_u32 v14, v14, v15
    v_lshlrev_b32 v14, 4, v14
    v_mov_b32 v15, 0x7fff0000
    v_cndmask_b32 v14, v15, v14, vcc
    s_lshl_b32 s54, s4, 7
    s_add_u32 s54, s54, s7
    s_mul_i32 s54, s54, 7168
    s_add_u32 s54, s54, 13631488
    s_sleep 4
    s_mov_b64 s[60:61], -1
    s_mov_b64 s[62:63], -1
    s_mov_b64 s[64:65], -1
    s_mov_b64 s[66:67], -1
    s_mov_b32 s59, 200000
L_pm_h4:
    s_mov_b64 exec, s[60:61]
    s_cbranch_execz L_pmsk_h4_0
    buffer_load_dwordx4 v[16:19], v6, s[32:35], s48 offen sc1
L_pmsk_h4_0:
    s_mov_b64 exec, s[62:63]
    s_cbranch_execz L_pmsk_h4_1
    buffer_load_dwordx4 v[20:23], v6, s[32:35], s49 offen sc1
L_pmsk_h4_1:
    s_mov_b64 exec, s[64:65]
    s_cbranch_execz L_pmsk_h4_2
    buffer_load_dwordx4 v[24:27], v6, s[32:35], s51 offen sc1
L_pmsk_h4_2:
    s_mov_b64 exec, s[66:67]
    s_cbranch_execz L_pmsk_h4_3
    buffer_load_dwordx4 v[28:31], v6, s[32:35], s53 offen sc1
L_pmsk_h4_3:
    s_mov_b64 exec, -1
    s_waitcnt vmcnt(0)
    v_xor_b32 v120, s92, v18
    v_xor_b32 v121, s93, v19
    v_or_b32 v120, v120, v121
    v_cmp_ne_u32 s[60:61], 0, v120
    v_xor_b32 v120, s92, v22
    v_xor_b32 v121, s93, v23
    v_or_b32 v120, v120, v121
    v_cmp_ne_u32 s[62:63], 0, v120
    v_xor_b32 v120, s92, v26
    v_xor_b32 v121, s93, v27
    v_or_b32 v120, v120, v121
    v_cmp_ne_u32 s[64:65], 0, v120
    v_xor_b32 v120, s92, v30
    v_xor_b32 v121, s93, v31
    v_or_b32 v120, v120, v121
    v_cmp_ne_u32 s[66:67], 0, v120
    s_nop 1
    s_or_b64 s[56:57], s[60:61], s[62:63]
    s_or_b64 s[56:57], s[56:57], s[64:65]
    s_or_b64 s[56:57], s[56:57], s[66:67]
    s_cmp_eq_u64 s[56:57], 0
    s_cbranch_scc1 L_pmok_h4
    s_sleep 2
    s_and_b32 s46, s59, 1
    s_cmp_eq_u32 s46, 0
    s_cselect_b64 vcc, -1, 0
    s_nop 1
    v_cndmask_b32 v6, v8, v9, vcc
    s_sub_u32 s59, s59, 1
    s_cmp_lg_u32 s59, 0
    s_cbranch_scc1 L_pm_h4
L_pmok_h4:
    v_add_f32 v16, v16, v20
    v_add_f32 v24, v24, v28
    v_add_f32 v16, v16, v24
    v_mov_b32 v20, v16
    s_nop 1
    v_permlane32_swap_b32 v16, v20
    s_nop 1
    v_add_f32 v16, v16, v20
    v_add_f32 v17, v17, v21
    v_add_f32 v25, v25, v29
    v_add_f32 v17, v17, v25
    v_mov_b32 v20, v17
    s_nop 1
    v_permlane32_swap_b32 v17, v20
    s_nop 1
    v_add_f32 v17, v17, v20
    v_cvt_pk_bf16_f32 v16, v16, v17
    ds_write_b32 v10, v16
    s_waitcnt lgkmcnt(0)
    ds_read_b128 v[4:7], v11
    s_waitcnt lgkmcnt(0)
    v_mfma_f32_16x16x32_bf16 v[80:83], v[48:51], v[4:7], 0
    v_mfma_f32_16x16x32_bf16 v[84:87], v[52:55], v[4:7], 0
    v_mfma_f32_16x16x32_bf16 v[88:91], v[56:59], v[4:7], 0
    v_mfma_f32_16x16x32_bf16 v[92:95], v[60:63], v[4:7], 0
    v_mfma_f32_16x16x32_bf16 v[96:99], v[64:67], v[4:7], 0
    v_mfma_f32_16x16x32_bf16 v[100:103], v[68:71], v[4:7], 0
    v_mfma_f32_16x16x32_bf16 v[104:107], v[72:75], v[4:7], 0
    v_mfma_f32_16x16x32_bf16 v[108:111], v[76:79], v[4:7], 0
    v_mov_b32 v34, s92
    v_mov_b32 v35, s93
    v_mov_b32 v38, s92
    v_mov_b32 v39, s93
    s_nop 5
    s_mov_b32 exec_lo, 0x00030003
    s_mov_b32 exec_hi, 0x00030003
    ds_write_b128 v12, v[80:83] offset:0
    ds_write_b128 v12, v[84:87] offset:16
    ds_write_b128 v12, v[88:91] offset:32
    ds_write_b128 v12, v[92:95] offset:48
    ds_write_b128 v12, v[96:99] offset:64
    ds_write_b128 v12, v[100:103] offset:80
    ds_write_b128 v12, v[104:107] offset:96
    ds_write_b128 v12, v[108:111] offset:112
    s_mov_b64 exec, -1
    s_waitcnt lgkmcnt(0)
    ds_read_b128 v[16:19], v13
    s_waitcnt lgkmcnt(0)
    v_mov_b32 v32, v16
    v_mov_b32 v33, v17
    v_mov_b32 v36, v18
    v_mov_b32 v37, v19
    buffer_store_dwordx4 v[32:35], v14, s[32:35], s54 offen sc1
    buffer_store_dwordx4 v[36:39], v14, s[32:35], s54 offen offset:3584 sc1
    s_cmp_lg_u32 s50, 7
    s_cbranch_scc1 L_end
    s_cmp_ge_u32 s7, 56
    s_cbranch_scc1 L_end
    v_lshrrev_b32 v6, 3, v1
    v_mul_u32_u24 v6, 7168, v6
    v_and_b32 v7, 7, v1
    v_and_b32 v8, 1, v7
    v_mul_u32_u24 v8, 3584, v8
    v_add_u32 v6, v6, v8
    v_lshrrev_b32 v8, 1, v7
    v_lshl_add_u32 v6, v8, 4, v6
    s_mul_i32 s48, s4, 917504
    s_lshl_b32 s49, s7, 6
    s_add_u32 s48, s48, s49
    s_add_u32 s48, s48, 13631488
    s_cmp_ge_u32 s7, 28
    s_cselect_b32 s49, 28, 0
    s_cselect_b32 s51, 896, 0
    s_sub_u32 s49, s7, s49
    s_lshl_b32 s49, s49, 4
    s_and_b32 s52, s49, 0xffe0
    s_lshr_b32 s49, s49, 2
    s_and_b32 s49, s49, 7
    s_add_u32 s52, s52, s49
    s_add_u32 s52, s52, s51
    s_mul_i32 s49, s4, 448
    s_add_u32 s52, s52, s49
    s_lshl_b32 s52, s52, 1
    v_lshrrev_b32 v8, 1, v7
    v_lshlrev_b32 v8, 1, v8
    v_and_b32 v7, 1, v7
    v_lshl_add_u32 v7, v7, 5, v8
    s_sleep 32
    s_mov_b64 s[60:61], -1
    s_mov_b64 s[62:63], -1
    s_mov_b64 s[64:65], -1
    s_mov_b64 s[66:67], -1
    s_mov_b64 s[68:69], -1
    s_mov_b64 s[70:71], -1
    s_mov_b64 s[72:73], -1
    s_mov_b64 s[74:75], -1
    s_mov_b64 s[76:77], -1
    s_mov_b64 s[78:79], -1
    s_mov_b64 s[80:81], -1
    s_mov_b64 s[82:83], -1
    s_mov_b64 s[84:85], -1
    s_mov_b64 s[86:87], -1
    s_mov_b64 s[88:89], -1
    s_mov_b64 s[90:91], -1
    s_mov_b32 s59, 200000
L_pm_h5:
    s_mov_b64 exec, s[60:61]
    s_cbranch_execz L_pmsk_h5_0
    s_add_u32 s49, s48, 0
    buffer_load_dwordx4 v[16:19], v6, s[32:35], s49 offen sc1
L_pmsk_h5_0:
    s_mov_b64 exec, s[62:63]
    s_cbranch_execz L_pmsk_h5_1
    s_add_u32 s49, s48, 57344
    buffer_load_dwordx4 v[20:23], v6, s[32:35], s49 offen sc1
L_pmsk_h5_1:
    s_mov_b64 exec, s[64:65]
    s_cbranch_execz L_pmsk_h5_2
    s_add_u32 s49, s48, 114688
    buffer_load_dwordx4 v[24:27], v6, s[32:35], s49 offen sc1
L_pmsk_h5_2:
    s_mov_b64 exec, s[66:67]
    s_cbranch_execz L_pmsk_h5_3
    s_add_u32 s49, s48, 172032
    buffer_load_dwordx4 v[28:31], v6, s[32:35], s49 offen sc1
L_pmsk_h5_3:
    s_mov_b64 exec, s[68:69]
    s_cbranch_execz L_pmsk_h5_4
    s_add_u32 s49, s48, 229376
    buffer_load_dwordx4 v[32:35], v6, s[32:35], s49 offen sc1
L_pmsk_h5_4:
    s_mov_b64 exec, s[70:71]
    s_cbranch_execz L_pmsk_h5_5
    s_add_u32 s49, s48, 286720
    buffer_load_dwordx4 v[36:39], v6, s[32:35], s49 offen sc1
L_pmsk_h5_5:
    s_mov_b64 exec, s[72:73]
    s_cbranch_execz L_pmsk_h5_6
    s_add_u32 s49, s48, 344064
    buffer_load_dwordx4 v[40:43], v6, s[32:35], s49 offen sc1
L_pmsk_h5_6:
    s_mov_b64 exec, s[74:75]
    s_cbranch_execz L_pmsk_h5_7
    s_add_u32 s49, s48, 401408
    buffer_load_dwordx4 v[44:47], v6, s[32:35], s49 offen sc1
L_pmsk_h5_7:
    s_mov_b64 exec, s[76:77]
    s_cbranch_execz L_pmsk_h5_8
    s_add_u32 s49, s48, 458752
    buffer_load_dwordx4 v[48:51], v6, s[32:35], s49 offen sc1
L_pmsk_h5_8:
    s_mov_b64 exec, s[78:79]
    s_cbranch_execz L_pmsk_h5_9
    s_add_u32 s49, s48, 516096
    buffer_load_dwordx4 v[52:55], v6, s[32:35], s49 offen sc1
L_pmsk_h5_9:
    s_mov_b64 exec, s[80:81]
    s_cbranch_execz L_pmsk_h5_10
    s_add_u32 s49, s48, 573440
    buffer_load_dwordx4 v[56:59], v6, s[32:35], s49 offen sc1
L_pmsk_h5_10:
    s_mov_b64 exec, s[82:83]
    s_cbranch_execz L_pmsk_h5_11
    s_add_u32 s49, s48, 630784
    buffer_load_dwordx4 v[60:63], v6, s[32:35], s49 offen sc1
L_pmsk_h5_11:
    s_mov_b64 exec, s[84:85]
    s_cbranch_execz L_pmsk_h5_12
    s_add_u32 s49, s48, 688128
    buffer_load_dwordx4 v[64:67], v6, s[32:35], s49 offen sc1
L_pmsk_h5_12:
    s_mov_b64 exec, s[86:87]
    s_cbranch_execz L_pmsk_h5_13
    s_add_u32 s49, s48, 745472
    buffer_load_dwordx4 v[68:71], v6, s[32:35], s49 offen sc1
L_pmsk_h5_13:
    s_mov_b64 exec, s[88:89]
    s_cbranch_execz L_pmsk_h5_14
    s_add_u32 s49, s48, 802816
    buffer_load_dwordx4 v[72:75], v6, s[32:35], s49 offen sc1
L_pmsk_h5_14:
    s_mov_b64 exec, s[90:91]
    s_cbranch_execz L_pmsk_h5_15
    s_add_u32 s49, s48, 860160
    buffer_load_dwordx4 v[76:79], v6, s[32:35], s49 offen sc1
L_pmsk_h5_15:
    s_mov_b64 exec, -1
    s_waitcnt vmcnt(0)
    v_xor_b32 v120, s92, v18
    v_xor_b32 v121, s93, v19
    v_or_b32 v120, v120, v121
    v_cmp_ne_u32 s[60:61], 0, v120
    v_xor_b32 v120, s92, v22
    v_xor_b32 v121, s93, v23
    v_or_b32 v120, v120, v121
    v_cmp_ne_u32 s[62:63], 0, v120
    v_xor_b32 v120, s92, v26
    v_xor_b32 v121, s93, v27
    v_or_b32 v120, v120, v121
    v_cmp_ne_u32 s[64:65], 0, v120
    v_xor_b32 v120, s92, v30
    v_xor_b32 v121, s93, v31
    v_or_b32 v120, v120, v121
    v_cmp_ne_u32 s[66:67], 0, v120
    v_xor_b32 v120, s92, v34
    v_xor_b32 v121, s93, v35
    v_or_b32 v120, v120, v121
    v_cmp_ne_u32 s[68:69], 0, v120
    v_xor_b32 v120, s92, v38
    v_xor_b32 v121, s93, v39
    v_or_b32 v120, v120, v121
    v_cmp_ne_u32 s[70:71], 0, v120
    v_xor_b32 v120, s92, v42
    v_xor_b32 v121, s93, v43
    v_or_b32 v120, v120, v121
    v_cmp_ne_u32 s[72:73], 0, v120
    v_xor_b32 v120, s92, v46
    v_xor_b32 v121, s93, v47
    v_or_b32 v120, v120, v121
    v_cmp_ne_u32 s[74:75], 0, v120
    v_xor_b32 v120, s92, v50
    v_xor_b32 v121, s93, v51
    v_or_b32 v120, v120, v121
    v_cmp_ne_u32 s[76:77], 0, v120
    v_xor_b32 v120, s92, v54
    v_xor_b32 v121, s93, v55
    v_or_b32 v120, v120, v121
    v_cmp_ne_u32 s[78:79], 0, v120
    v_xor_b32 v120, s92, v58
    v_xor_b32 v121, s93, v59
    v_or_b32 v120, v120, v121
    v_cmp_ne_u32 s[80:81], 0, v120
    v_xor_b32 v120, s92, v62
    v_xor_b32 v121, s93, v63
    v_or_b32 v120, v120, v121
    v_cmp_ne_u32 s[82:83], 0, v120
    v_xor_b32 v120, s92, v66
    v_xor_b32 v121, s93, v67
    v_or_b32 v120, v120, v121
    v_cmp_ne_u32 s[84:85], 0, v120
    v_xor_b32 v120, s92, v70
    v_xor_b32 v121, s93, v71
    v_or_b32 v120, v120, v121
    v_cmp_ne_u32 s[86:87], 0, v120
    v_xor_b32 v120, s92, v74
    v_xor_b32 v121, s93, v75
    v_or_b32 v120, v120, v121
    v_cmp_ne_u32 s[88:89], 0, v120
    v_xor_b32 v120, s92, v78
    v_xor_b32 v121, s93, v79
    v_or_b32 v120, v120, v121
    v_cmp_ne_u32 s[90:91], 0, v120
    s_nop 1
    s_or_b64 s[56:57], s[60:61], s[62:63]
    s_or_b64 s[56:57], s[56:57], s[64:65]
    s_or_b64 s[56:57], s[56:57], s[66:67]
    s_or_b64 s[56:57], s[56:57], s[68:69]
    s_or_b64 s[56:57], s[56:57], s[70:71]
    s_or_b64 s[56:57], s[56:57], s[72:73]
    s_or_b64 s[56:57], s[56:57], s[74:75]
    s_or_b64 s[56:57], s[56:57], s[76:77]
    s_or_b64 s[56:57], s[56:57], s[78:79]
    s_or_b64 s[56:57], s[56:57], s[80:81]
    s_or_b64 s[56:57], s[56:57], s[82:83]
    s_or_b64 s[56:57], s[56:57], s[84:85]
    s_or_b64 s[56:57], s[56:57], s[86:87]
    s_or_b64 s[56:57], s[56:57], s[88:89]
    s_or_b64 s[56:57], s[56:57], s[90:91]
    s_cmp_eq_u64 s[56:57], 0
    s_cbranch_scc1 L_pmok_h5
    s_sleep 8
    s_sub_u32 s59, s59, 1
    s_cmp_lg_u32 s59, 0
    s_cbranch_scc1 L_pm_h5
L_pmok_h5:
    v_add_f32 v16, v16, v48
    v_add_f32 v17, v17, v49
    v_add_f32 v20, v20, v52
    v_add_f32 v21, v21, v53
    v_add_f32 v24, v24, v56
    v_add_f32 v25, v25, v57
    v_add_f32 v28, v28, v60
    v_add_f32 v29, v29, v61
    v_add_f32 v32, v32, v64
    v_add_f32 v33, v33, v65
    v_add_f32 v36, v36, v68
    v_add_f32 v37, v37, v69
    v_add_f32 v40, v40, v72
    v_add_f32 v41, v41, v73
    v_add_f32 v44, v44, v76
    v_add_f32 v45, v45, v77
    v_add_f32 v16, v16, v32
    v_add_f32 v17, v17, v33
    v_add_f32 v20, v20, v36
    v_add_f32 v21, v21, v37
    v_add_f32 v24, v24, v40
    v_add_f32 v25, v25, v41
    v_add_f32 v28, v28, v44
    v_add_f32 v29, v29, v45
    v_add_f32 v16, v16, v24
    v_add_f32 v17, v17, v25
    v_add_f32 v20, v20, v28
    v_add_f32 v21, v21, v29
    v_add_f32 v16, v16, v20
    v_add_f32 v17, v17, v21
    s_nop 1
    v_add_f32_dpp v16, v16, v16 row_ror:8 row_mask:0xf bank_mask:0xf
    v_mov_b32 v20, v16
    s_nop 1
    v_permlane16_swap_b32 v16, v20
    s_nop 1
    v_add_f32 v16, v16, v20
    v_mov_b32 v20, v16
    s_nop 1
    v_permlane32_swap_b32 v16, v20
    s_nop 1
    v_add_f32 v16, v16, v20
    s_nop 1
    v_add_f32_dpp v17, v17, v17 row_ror:8 row_mask:0xf bank_mask:0xf
    v_mov_b32 v20, v17
    s_nop 1
    v_permlane16_swap_b32 v17, v20
    s_nop 1
    v_add_f32 v17, v17, v20
    v_mov_b32 v20, v17
    s_nop 1
    v_permlane32_swap_b32 v17, v20
    s_nop 1
    v_add_f32 v17, v17, v20
    v_cvt_pk_bf16_f32 v16, v16, v17
    s_mov_b64 exec, 0xff
    buffer_store_short v16, v7, s[36:39], s52 offen
    buffer_store_short_d16_hi v16, v7, s[36:39], s52 offen offset:16
    s_cmp_lg_u32 s7, 0
    s_cbranch_scc1 L_noep
    s_lshl_b32 s46, s4, 7
    s_add_u32 s46, s46, 11010048
    v_mov_b32 v20, s92
    v_mov_b32 v21, s93
    v_mov_b32 v22, 0
    s_mov_b64 exec, 1
    buffer_store_dwordx2 v[20:21], v22, s[32:35], s46 offen sc1
L_noep:
    s_mov_b64 exec, -1
L_end:
    s_endpgm
.section .rodata,"a"
.p2align 6
.amdhsa_kernel concat_heads__compressed_kv_cla__compressed_kv_cla__decode_kernel
  .amdhsa_next_free_vgpr 128
  .amdhsa_next_free_sgpr 96
  .amdhsa_accum_offset 128
  .amdhsa_group_segment_fixed_size 0
  .amdhsa_kernarg_size 120
  .amdhsa_user_sgpr_count 2
  .amdhsa_user_sgpr_kernarg_segment_ptr 1
  .amdhsa_system_sgpr_workgroup_id_x 1
.end_amdhsa_kernel
```
